```python
import torch

def _softmax(x, axis=-1):
    return torch.softmax(x, dim=axis)
def _gelu(x):
    return torch.nn.functional.gelu(x, approximate="tanh")
def _silu(x):
    return torch.nn.functional.silu(x)
def _sigmoid(x):
    return torch.sigmoid(x)
def _layernorm(x, axis=-1, eps=1e-5):
    m = x.mean(dim=axis, keepdim=True)
    v = x.var(dim=axis, keepdim=True, unbiased=False)
    return (x - m) / torch.sqrt(v + eps)
def _scatter_add(tgt, idx, src, axis=0):
    return tgt.clone().index_add_(axis, idx, src)
def _segment_sum(src, seg, n):
    out = torch.zeros((n,) + src.shape[1:], dtype=src.dtype)
    return out.index_add_(0, seg, src)
def _pad(x, pw):
    flat = tuple(v for pair in reversed(pw) for v in pair)
    return torch.nn.functional.pad(x, flat)

kernel_name = 'recurrent_scan__softmax_full_mha__dense_activation_relu__prompt'

def setup_inputs():

    _w = (lambda a: (lambda t: t.to(torch.bfloat16) if t.is_floating_point() else t)(torch.as_tensor(a)))
    def _A_setup():
        B, S, D = 1, 2048, 640
        return {
            "x": _w((lambda *s: torch.randn(*s, dtype=torch.bfloat16) * 0.05)(B, S, D)),
            "wqkv": _w((lambda *s: torch.randn(*s, dtype=torch.bfloat16) * 0.05)(D, 3 * D)),
            "wo": _w((lambda *s: torch.randn(*s, dtype=torch.bfloat16) * 0.05)(D, D)),
        }
    _A_in = _A_setup()

    def _B_setup():
        B, S, D, Dff = 1, 2048, 640, 1536
        return {
            "x": _w((lambda *s: torch.randn(*s, dtype=torch.bfloat16) * 0.05)(B, S, D)),
            "w1": _w((lambda *s: torch.randn(*s, dtype=torch.bfloat16) * 0.05)(D, Dff)),
            "w2": _w((lambda *s: torch.randn(*s, dtype=torch.bfloat16) * 0.05)(Dff, D)),
        }
    _B_in = _B_setup()

    return {
        "A_x": _A_in["x"],
        "A_wqkv": _A_in["wqkv"],
        "A_wo": _A_in["wo"],
        "B_x": _B_in["x"],
        "B_w1": _B_in["w1"],
        "B_w2": _B_in["w2"],
    }

def reference(A_x, A_wqkv, A_wo, B_x, B_w1, B_w2):
    def _A_ref(x, wqkv, wo):
        B, S, D = x.shape
        H = 32; Dh = D // H
        qkv = (lambda x, *d: x.permute(*d))((x @ wqkv).reshape(B, S, 3, H, Dh), 2, 0, 3, 1, 4)
        q, k, v = qkv[0], qkv[1], qkv[2]
        scale = Dh ** -0.5
        scores = torch.einsum("bhqd,bhkd->bhqk", q, k) * scale
        p = _softmax(scores, axis=-1)
        o = torch.einsum("bhqk,bhkd->bhqd", p, v)
        return (lambda x, *d: x.permute(*d))(o, 0, 2, 1, 3).reshape(B, S, D) @ wo

    def _B_ref(x, w1, w2):
        h = torch.einsum("bsd,df->bsf", x, w1)
        zero = torch.zeros_like(h)
        h = torch.maximum(h, zero)
        return torch.einsum("bsf,fd->bsd", h, w2)

    x = A_x
    xn = _layernorm(x, axis=-1)
    s = _A_ref(xn, A_wqkv, A_wo)
    g = _silu(_B_ref(xn, B_w1, B_w2))
    return x + s * g
```

```asm
; @launch grid=(256,1,1) block=(512,1,1) lds=161792
.amdgcn_target "amdgcn-amd-amdhsa--gfx950"
    .text
    .globl recurrent_scan__softmax_full_mha__dense_activation_relu__prompt_kernel
    .p2align 8
    .type recurrent_scan__softmax_full_mha__dense_activation_relu__prompt_kernel,@function
recurrent_scan__softmax_full_mha__dense_activation_relu__prompt_kernel:
    s_cmp_ge_u32 s2, 256
    s_cbranch_scc1 L_p1_exit
    s_load_dwordx4 s[4:7], s[0:1], 0
    s_load_dwordx2 s[8:9], s[0:1], 16
    s_load_dwordx4 s[12:15], s[0:1], 32
    s_load_dwordx2 s[16:17], s[0:1], 64
    s_load_dwordx2 s[18:19], s[0:1], 56
    v_lshrrev_b32 v2, 6, v0
    v_and_b32 v1, 63, v0
    v_readfirstlane_b32 s32, v2
    s_and_b32 s41, s2, 7
    s_lshr_b32 s42, s2, 3
    s_and_b32 s39, s42, 3
    s_and_b32 s3, s41, 1
    s_lshl_b32 s3, s3, 2
    s_add_u32 s33, s39, s3
    s_lshr_b32 s34, s41, 1
    s_mul_i32 s34, s34, 7
    s_lshr_b32 s3, s42, 2
    s_add_u32 s34, s34, s3
    s_cmp_ge_u32 s3, 7
    s_cbranch_scc1 L_p1_spare
    s_cmp_ge_u32 s34, 27
    s_cbranch_scc1 L_p1_spare
    s_mov_b32 s39, 0
    s_cmp_ge_u32 s34, 15
    s_mov_b32 s35, 3840
    s_cselect_b32 s35, 3072, s35
    s_cselect_b32 s3, 15, 0
    s_sub_u32 s3, s34, s3
    s_lshl_b32 s37, s3, 8
    s_mul_i32 s36, s33, 327680
    s_lshl_b32 s38, s32, 10
    s_lshl_b32 s54, s35, 6
    s_and_b32 s46, s32, 3
    s_lshr_b32 s47, s32, 2
    s_and_b32 s48, s32, 1
    s_lshr_b32 s53, s46, 1
    v_lshrrev_b32 v12, 4, v1
    s_lshl_b32 s3, s32, 2
    v_add_u32 v13, s3, v12
    v_xor_b32 v5, v13, v1
    v_and_b32 v5, 7, v5
    v_lshrrev_b32 v4, 3, v1
    v_lshl_add_u32 v4, s32, 3, v4
    v_mul_u32_u24 v4, 1280, v4
    v_lshl_add_u32 v194, v5, 4, v4
    v_add_u32 v195, 81920, v194
    v_add_u32 v196, 163840, v194
    v_add_u32 v197, 245760, v194
    v_lshlrev_b32 v5, 2, v12
    v_xor_b32 v5, v5, v1
    v_and_b32 v5, 15, v5
    v_mul_u32_u24 v4, s35, v13
    v_lshl_add_u32 v198, v5, 4, v4
    s_lshl_b32 s3, s35, 5
    v_add_u32 v199, s3, v198
    v_and_b32 v192, 31, v1
    v_lshrrev_b32 v193, 5, v1
    v_bfe_u32 v14, v1, 1, 3
    s_lshl_b32 s3, s53, 1
    v_add_u32 v15, s3, v193
    v_xor_b32 v14, v14, v15
    v_lshl_add_u32 v15, s46, 6, v192
    v_lshlrev_b32 v15, 7, v15
    v_lshl_add_u32 v4, v14, 4, v15
    v_xor_b32 v5, 32, v4
    v_xor_b32 v6, 64, v4
    v_xor_b32 v7, 0x60, v4
    v_bfe_u32 v14, v1, 2, 2
    v_lshl_add_u32 v15, v193, 3, v14
    s_lshl_b32 s41, s53, 4
    v_add_u32 v15, s41, v15
    s_lshl_b32 s3, s47, 1
    s_add_u32 s3, s3, s48
    v_xor_b32 v14, s3, v14
    v_lshlrev_b32 v14, 6, v14
    v_lshl_add_u32 v15, v15, 8, v14
    v_and_b32 v14, 1, v12
    v_lshl_add_u32 v15, v14, 5, v15
    v_and_b32 v14, 3, v1
    v_lshl_add_u32 v15, v14, 3, v15
    v_add_u32 v8, 98304, v15
    v_xor_b32 v9, 0x1000, v8
    v_xor_b32 v10, 64, v8
    v_xor_b32 v11, 0x1040, v8
    v_and_b32 v14, 127, v0
    v_lshlrev_b32 v14, 2, v14
    v_add_u32 v14, 147456, v14
    v_mov_b32 v12, 0
    v_mov_b32 v13, 0
    ds_write_b32 v14, v12
    s_mov_b32 s40, 0
    s_mov_b32 s43, 0
    s_mov_b32 s45, 0xffff0000
    s_waitcnt lgkmcnt(0)
    s_mov_b32 s20, s4
    s_mov_b32 s21, s5
    s_mov_b32 s22, 2621440
    s_mov_b32 s23, 0x00020000
    s_cmp_ge_u32 s34, 15
    s_cselect_b32 s24, s12, s6
    s_cselect_b32 s25, s13, s7
    s_mov_b32 s26, 2457600
    s_cselect_b32 s26, 1966080, s26
    s_mov_b32 s27, 0x00020000
    v_mov_b32 v29, 0
    v_mov_b32 v16, 0
    v_mov_b32 v17, 0
    s_mov_b32 s28, s16
    s_mov_b32 s29, s17
    s_mov_b32 s30, 23068672
    s_mov_b32 s31, 0x00020000
    s_mov_b32 s56, s18
    s_mov_b32 s57, s19
    s_mov_b32 s58, 256
    s_mov_b32 s59, 0x00020000
L_p1_pre:
    s_lshl_b32 s60, s43, 15
    s_add_u32 s60, s60, s38
    s_lshl_b32 s61, s43, 14
    s_add_u32 s61, s61, s38
    s_add_u32 s61, s61, 98304
    s_lshl_b32 s51, s39, 7
    s_add_u32 s51, s51, s36
    s_mul_i32 s52, s54, s39
    s_add_u32 s52, s52, s37
    s_add_u32 s39, s39, 1
    s_cmp_ge_u32 s39, 10
    s_cselect_b32 s39, 0, s39
    s_add_u32 m0, s60, 0
    s_nop 0
    buffer_load_dwordx4 v194, s[20:23], s51 offen lds
    s_add_u32 m0, s60, 8192
    s_nop 0
    buffer_load_dwordx4 v195, s[20:23], s51 offen lds
    s_add_u32 m0, s60, 16384
    s_nop 0
    buffer_load_dwordx4 v196, s[20:23], s51 offen lds
    s_add_u32 m0, s60, 24576
    s_nop 0
    buffer_load_dwordx4 v197, s[20:23], s51 offen lds
    s_add_u32 m0, s61, 0
    s_nop 0
    buffer_load_dwordx4 v198, s[24:27], s52 offen lds
    s_add_u32 m0, s61, 8192
    s_nop 0
    buffer_load_dwordx4 v199, s[24:27], s52 offen lds
    s_add_u32 s43, s43, 1
    s_cmp_lt_u32 s43, 2
    s_barrier
    s_cbranch_scc1 L_p1_pre
    s_lshl_b32 s60, s43, 15
    s_add_u32 s60, s60, s38
    s_lshl_b32 s61, s43, 14
    s_add_u32 s61, s61, s38
    s_add_u32 s61, s61, 98304
    s_lshl_b32 s51, s39, 7
    s_add_u32 s51, s51, s36
    s_mul_i32 s52, s54, s39
    s_add_u32 s52, s52, s37
    s_add_u32 s39, s39, 1
    s_cmp_ge_u32 s39, 10
    s_cselect_b32 s39, 0, s39
    s_mov_b32 s43, 0
    s_waitcnt vmcnt(6)
    s_barrier
    ds_read_b128 v[32:35], v4
    ds_read_b128 v[36:39], v4 offset:4096
    ds_read_b64_tr_b16 v[40:41], v8 offset:0
    ds_read_b64_tr_b16 v[42:43], v8 offset:1024
    ds_read_b64_tr_b16 v[44:45], v10 offset:0
    ds_read_b64_tr_b16 v[46:47], v10 offset:1024
    s_cmp_ge_u32 s34, 10
    s_cbranch_scc0 L_p1_ent0
    s_cmp_lt_u32 s34, 15
    s_cbranch_scc1 L_p1_ent1
L_p1_ent0:
    s_waitcnt lgkmcnt(0)
    v_mfma_f32_32x32x16_bf16 v[64:79], v[40:43], v[32:35], 0
    s_add_u32 m0, s60, 0
    ds_read_b128 v[48:51], v5
    buffer_load_dwordx4 v194, s[20:23], s51 offen lds
    s_add_u32 m0, s60, 8192
    ds_read_b128 v[52:55], v5 offset:4096
    buffer_load_dwordx4 v195, s[20:23], s51 offen lds
    v_lshlrev_b32 v14, 16, v40
    v_and_b32 v15, s45, v40
    v_add_f32 v12, v12, v14
    v_add_f32 v13, v13, v15
    v_mfma_f32_32x32x16_bf16 v[80:95], v[40:43], v[36:39], 0
    s_add_u32 m0, s60, 16384
    ds_read_b64_tr_b16 v[56:57], v9 offset:0
    buffer_load_dwordx4 v196, s[20:23], s51 offen lds
    s_add_u32 m0, s60, 24576
    ds_read_b64_tr_b16 v[58:59], v9 offset:1024
    buffer_load_dwordx4 v197, s[20:23], s51 offen lds
    v_lshlrev_b32 v14, 16, v41
    v_and_b32 v15, s45, v41
    v_add_f32 v12, v12, v14
    v_add_f32 v13, v13, v15
    v_mfma_f32_32x32x16_bf16 v[96:111], v[44:47], v[32:35], 0
    s_add_u32 m0, s61, 0
    ds_read_b64_tr_b16 v[60:61], v11 offset:0
    buffer_load_dwordx4 v198, s[24:27], s52 offen lds
    s_add_u32 m0, s61, 8192
    ds_read_b64_tr_b16 v[62:63], v11 offset:1024
    buffer_load_dwordx4 v199, s[24:27], s52 offen lds
    v_lshlrev_b32 v14, 16, v42
    v_and_b32 v15, s45, v42
    v_add_f32 v12, v12, v14
    v_add_f32 v13, v13, v15
    v_mfma_f32_32x32x16_bf16 v[112:127], v[44:47], v[36:39], 0
    v_lshlrev_b32 v14, 16, v43
    v_and_b32 v15, s45, v43
    v_add_f32 v12, v12, v14
    v_add_f32 v13, v13, v15
    s_branch L_p1_loop0_k1
L_p1_loop0:
    s_waitcnt lgkmcnt(0)
    v_mfma_f32_32x32x16_bf16 v[64:79], v[40:43], v[32:35], v[64:79]
    ds_read_b128 v[48:51], v5
    ds_read_b128 v[52:55], v5 offset:4096
    v_lshlrev_b32 v14, 16, v40
    v_and_b32 v15, s45, v40
    v_add_f32 v12, v12, v14
    v_add_f32 v13, v13, v15
    v_mfma_f32_32x32x16_bf16 v[80:95], v[40:43], v[36:39], v[80:95]
    ds_read_b64_tr_b16 v[56:57], v9 offset:0
    ds_read_b64_tr_b16 v[58:59], v9 offset:1024
    v_lshlrev_b32 v14, 16, v41
    v_and_b32 v15, s45, v41
    v_add_f32 v12, v12, v14
    v_add_f32 v13, v13, v15
    v_mfma_f32_32x32x16_bf16 v[96:111], v[44:47], v[32:35], v[96:111]
    ds_read_b64_tr_b16 v[60:61], v11 offset:0
    ds_read_b64_tr_b16 v[62:63], v11 offset:1024
    v_lshlrev_b32 v14, 16, v42
    v_and_b32 v15, s45, v42
    v_add_f32 v12, v12, v14
    v_add_f32 v13, v13, v15
    v_mfma_f32_32x32x16_bf16 v[112:127], v[44:47], v[36:39], v[112:127]
    v_lshlrev_b32 v14, 16, v43
    v_and_b32 v15, s45, v43
    v_add_f32 v12, v12, v14
    v_add_f32 v13, v13, v15
L_p1_loop0_k1:
    s_waitcnt lgkmcnt(0)
    v_mfma_f32_32x32x16_bf16 v[64:79], v[56:59], v[48:51], v[64:79]
    ds_read_b128 v[32:35], v6
    ds_read_b128 v[36:39], v6 offset:4096
    s_lshl_b32 s60, s43, 15
    s_add_u32 s60, s60, s38
    s_lshl_b32 s61, s43, 14
    s_add_u32 s61, s61, s38
    s_add_u32 s61, s61, 98304
    v_mfma_f32_32x32x16_bf16 v[80:95], v[56:59], v[52:55], v[80:95]
    ds_read_b64_tr_b16 v[40:41], v8 offset:8192
    ds_read_b64_tr_b16 v[42:43], v8 offset:9216
    s_lshl_b32 s51, s39, 7
    s_add_u32 s51, s51, s36
    s_mul_i32 s52, s54, s39
    s_add_u32 s52, s52, s37
    s_add_u32 s39, s39, 1
    s_cmp_ge_u32 s39, 10
    s_cselect_b32 s39, 0, s39
    v_mfma_f32_32x32x16_bf16 v[96:111], v[60:63], v[48:51], v[96:111]
    ds_read_b64_tr_b16 v[44:45], v10 offset:8192
    ds_read_b64_tr_b16 v[46:47], v10 offset:9216
    s_cmp_eq_u32 s43, 2
    s_mov_b32 s49, 32768
    s_cselect_b32 s49, 4294901760, s49
    s_mov_b32 s50, 16384
    s_cselect_b32 s50, 4294934528, s50
    s_cselect_b32 s43, -1, s43
    s_add_u32 s43, s43, 1
    v_mfma_f32_32x32x16_bf16 v[112:127], v[60:63], v[52:55], v[112:127]
L_p1_loop0_k2:
    s_waitcnt lgkmcnt(0)
    v_mfma_f32_32x32x16_bf16 v[64:79], v[40:43], v[32:35], v[64:79]
    ds_read_b128 v[48:51], v7
    ds_read_b128 v[52:55], v7 offset:4096
    v_lshlrev_b32 v14, 16, v40
    v_and_b32 v15, s45, v40
    v_add_f32 v12, v12, v14
    v_add_f32 v13, v13, v15
    v_mfma_f32_32x32x16_bf16 v[80:95], v[40:43], v[36:39], v[80:95]
    ds_read_b64_tr_b16 v[56:57], v9 offset:8192
    ds_read_b64_tr_b16 v[58:59], v9 offset:9216
    v_lshlrev_b32 v14, 16, v41
    v_and_b32 v15, s45, v41
    v_add_f32 v12, v12, v14
    v_add_f32 v13, v13, v15
    v_mfma_f32_32x32x16_bf16 v[96:111], v[44:47], v[32:35], v[96:111]
    ds_read_b64_tr_b16 v[60:61], v11 offset:8192
    ds_read_b64_tr_b16 v[62:63], v11 offset:9216
    v_lshlrev_b32 v14, 16, v42
    v_and_b32 v15, s45, v42
    v_add_f32 v12, v12, v14
    v_add_f32 v13, v13, v15
    v_mfma_f32_32x32x16_bf16 v[112:127], v[44:47], v[36:39], v[112:127]
    v_add_u32 v4, s49, v4
    v_add_u32 v8, s50, v8
    v_add_u32 v5, s49, v5
    v_add_u32 v9, s50, v9
    v_add_u32 v6, s49, v6
    v_add_u32 v10, s50, v10
    v_add_u32 v7, s49, v7
    v_add_u32 v11, s50, v11
    v_lshlrev_b32 v14, 16, v43
    v_and_b32 v15, s45, v43
    v_add_f32 v12, v12, v14
    v_add_f32 v13, v13, v15
    s_cmp_ge_u32 s40, 7
    s_cbranch_scc1 L_p1_loop0_tail
    s_waitcnt vmcnt(6) lgkmcnt(0)
    s_barrier
    v_mfma_f32_32x32x16_bf16 v[64:79], v[56:59], v[48:51], v[64:79]
    s_add_u32 m0, s60, 0
    ds_read_b128 v[32:35], v4
    buffer_load_dwordx4 v194, s[20:23], s51 offen lds
    s_add_u32 m0, s60, 8192
    ds_read_b128 v[36:39], v4 offset:4096
    buffer_load_dwordx4 v195, s[20:23], s51 offen lds
    v_mfma_f32_32x32x16_bf16 v[80:95], v[56:59], v[52:55], v[80:95]
    s_add_u32 m0, s60, 16384
    ds_read_b64_tr_b16 v[40:41], v8 offset:0
    buffer_load_dwordx4 v196, s[20:23], s51 offen lds
    s_add_u32 m0, s60, 24576
    ds_read_b64_tr_b16 v[42:43], v8 offset:1024
    buffer_load_dwordx4 v197, s[20:23], s51 offen lds
    v_mfma_f32_32x32x16_bf16 v[96:111], v[60:63], v[48:51], v[96:111]
    s_add_u32 m0, s61, 0
    ds_read_b64_tr_b16 v[44:45], v10 offset:0
    buffer_load_dwordx4 v198, s[24:27], s52 offen lds
    s_add_u32 m0, s61, 8192
    ds_read_b64_tr_b16 v[46:47], v10 offset:1024
    buffer_load_dwordx4 v199, s[24:27], s52 offen lds
    v_mfma_f32_32x32x16_bf16 v[112:127], v[60:63], v[52:55], v[112:127]
    s_add_u32 s40, s40, 1
    s_branch L_p1_loop0
L_p1_loop0_tail:
    s_cmp_ge_u32 s40, 9
    s_cbranch_scc1 L_p1_loop0_last
    s_cmp_ge_u32 s40, 8
    s_cbranch_scc1 L_p1_loop0_w0
    s_waitcnt vmcnt(6) lgkmcnt(0)
    s_barrier
    s_lshl_b32 s41, s33, 2
    v_mov_b32 v29, s41
    buffer_load_dword v28, v29, s[56:59], 0 offen sc1
    s_branch L_p1_loop0_go
L_p1_loop0_w0:
    s_waitcnt vmcnt(0) lgkmcnt(0)
    s_barrier
    s_mov_b32 s42, 0
L_p1_loop0_spin:
    v_readfirstlane_b32 s41, v28
    s_add_u32 s42, s42, 1
    s_cmp_ge_u32 s41, 5
    s_cbranch_scc1 L_p1_loop0_got
    s_cmp_ge_u32 s42, 0x40000
    s_cbranch_scc1 L_p1_loop0_got
    s_sleep 2
    buffer_load_dword v28, v29, s[56:59], 0 offen sc1
    s_waitcnt vmcnt(0)
    s_branch L_p1_loop0_spin
L_p1_loop0_got:
    s_lshl_b32 s41, s33, 10
    s_lshl_b32 s42, s46, 8
    s_add_u32 s41, s41, s42
    s_add_u32 s41, s41, 22183936
    s_add_u32 s42, s41, 8192
    v_lshlrev_b32 v30, 2, v192
    buffer_load_dword v24, v30, s[28:31], s41 offen sc1
    buffer_load_dword v25, v30, s[28:31], s42 offen sc1
    buffer_load_dword v26, v30, s[28:31], s41 offen offset:128 sc1
    buffer_load_dword v27, v30, s[28:31], s42 offen offset:128 sc1
L_p1_loop0_go:
    v_mfma_f32_32x32x16_bf16 v[64:79], v[56:59], v[48:51], v[64:79]
    ds_read_b128 v[32:35], v4
    ds_read_b128 v[36:39], v4 offset:4096
    v_mfma_f32_32x32x16_bf16 v[80:95], v[56:59], v[52:55], v[80:95]
    ds_read_b64_tr_b16 v[40:41], v8 offset:0
    ds_read_b64_tr_b16 v[42:43], v8 offset:1024
    v_mfma_f32_32x32x16_bf16 v[96:111], v[60:63], v[48:51], v[96:111]
    ds_read_b64_tr_b16 v[44:45], v10 offset:0
    ds_read_b64_tr_b16 v[46:47], v10 offset:1024
    v_mfma_f32_32x32x16_bf16 v[112:127], v[60:63], v[52:55], v[112:127]
    s_add_u32 s40, s40, 1
    s_branch L_p1_loop0
L_p1_loop0_last:
    s_waitcnt lgkmcnt(0)
    v_mfma_f32_32x32x16_bf16 v[64:79], v[56:59], v[48:51], v[64:79]
    v_mfma_f32_32x32x16_bf16 v[80:95], v[56:59], v[52:55], v[80:95]
    v_mfma_f32_32x32x16_bf16 v[96:111], v[60:63], v[48:51], v[96:111]
    v_mfma_f32_32x32x16_bf16 v[112:127], v[60:63], v[52:55], v[112:127]
    s_branch L_p1_stats
L_p1_ent1:
    s_waitcnt lgkmcnt(0)
    v_mfma_f32_32x32x16_bf16 v[64:79], v[32:35], v[40:43], 0
    s_add_u32 m0, s60, 0
    ds_read_b128 v[48:51], v5
    buffer_load_dwordx4 v194, s[20:23], s51 offen lds
    s_add_u32 m0, s60, 8192
    ds_read_b128 v[52:55], v5 offset:4096
    buffer_load_dwordx4 v195, s[20:23], s51 offen lds
    v_lshlrev_b32 v14, 16, v40
    v_and_b32 v15, s45, v40
    v_add_f32 v12, v12, v14
    v_add_f32 v13, v13, v15
    v_mfma_f32_32x32x16_bf16 v[80:95], v[36:39], v[40:43], 0
    s_add_u32 m0, s60, 16384
    ds_read_b64_tr_b16 v[56:57], v9 offset:0
    buffer_load_dwordx4 v196, s[20:23], s51 offen lds
    s_add_u32 m0, s60, 24576
    ds_read_b64_tr_b16 v[58:59], v9 offset:1024
    buffer_load_dwordx4 v197, s[20:23], s51 offen lds
    v_lshlrev_b32 v14, 16, v41
    v_and_b32 v15, s45, v41
    v_add_f32 v12, v12, v14
    v_add_f32 v13, v13, v15
    v_mfma_f32_32x32x16_bf16 v[96:111], v[32:35], v[44:47], 0
    s_add_u32 m0, s61, 0
    ds_read_b64_tr_b16 v[60:61], v11 offset:0
    buffer_load_dwordx4 v198, s[24:27], s52 offen lds
    s_add_u32 m0, s61, 8192
    ds_read_b64_tr_b16 v[62:63], v11 offset:1024
    buffer_load_dwordx4 v199, s[24:27], s52 offen lds
    v_lshlrev_b32 v14, 16, v42
    v_and_b32 v15, s45, v42
    v_add_f32 v12, v12, v14
    v_add_f32 v13, v13, v15
    v_mfma_f32_32x32x16_bf16 v[112:127], v[36:39], v[44:47], 0
    v_lshlrev_b32 v14, 16, v43
    v_and_b32 v15, s45, v43
    v_add_f32 v12, v12, v14
    v_add_f32 v13, v13, v15
    s_branch L_p1_loop1_k1
L_p1_loop1:
    s_waitcnt lgkmcnt(0)
    v_mfma_f32_32x32x16_bf16 v[64:79], v[32:35], v[40:43], v[64:79]
    ds_read_b128 v[48:51], v5
    ds_read_b128 v[52:55], v5 offset:4096
    v_lshlrev_b32 v14, 16, v40
    v_and_b32 v15, s45, v40
    v_add_f32 v12, v12, v14
    v_add_f32 v13, v13, v15
    v_mfma_f32_32x32x16_bf16 v[80:95], v[36:39], v[40:43], v[80:95]
    ds_read_b64_tr_b16 v[56:57], v9 offset:0
    ds_read_b64_tr_b16 v[58:59], v9 offset:1024
    v_lshlrev_b32 v14, 16, v41
    v_and_b32 v15, s45, v41
    v_add_f32 v12, v12, v14
    v_add_f32 v13, v13, v15
    v_mfma_f32_32x32x16_bf16 v[96:111], v[32:35], v[44:47], v[96:111]
    ds_read_b64_tr_b16 v[60:61], v11 offset:0
    ds_read_b64_tr_b16 v[62:63], v11 offset:1024
    v_lshlrev_b32 v14, 16, v42
    v_and_b32 v15, s45, v42
    v_add_f32 v12, v12, v14
    v_add_f32 v13, v13, v15
    v_mfma_f32_32x32x16_bf16 v[112:127], v[36:39], v[44:47], v[112:127]
    v_lshlrev_b32 v14, 16, v43
    v_and_b32 v15, s45, v43
    v_add_f32 v12, v12, v14
    v_add_f32 v13, v13, v15
L_p1_loop1_k1:
    s_waitcnt lgkmcnt(0)
    v_mfma_f32_32x32x16_bf16 v[64:79], v[48:51], v[56:59], v[64:79]
    ds_read_b128 v[32:35], v6
    ds_read_b128 v[36:39], v6 offset:4096
    s_lshl_b32 s60, s43, 15
    s_add_u32 s60, s60, s38
    s_lshl_b32 s61, s43, 14
    s_add_u32 s61, s61, s38
    s_add_u32 s61, s61, 98304
    v_mfma_f32_32x32x16_bf16 v[80:95], v[52:55], v[56:59], v[80:95]
    ds_read_b64_tr_b16 v[40:41], v8 offset:8192
    ds_read_b64_tr_b16 v[42:43], v8 offset:9216
    s_lshl_b32 s51, s39, 7
    s_add_u32 s51, s51, s36
    s_mul_i32 s52, s54, s39
    s_add_u32 s52, s52, s37
    s_add_u32 s39, s39, 1
    s_cmp_ge_u32 s39, 10
    s_cselect_b32 s39, 0, s39
    v_mfma_f32_32x32x16_bf16 v[96:111], v[48:51], v[60:63], v[96:111]
    ds_read_b64_tr_b16 v[44:45], v10 offset:8192
    ds_read_b64_tr_b16 v[46:47], v10 offset:9216
    s_cmp_eq_u32 s43, 2
    s_mov_b32 s49, 32768
    s_cselect_b32 s49, 4294901760, s49
    s_mov_b32 s50, 16384
    s_cselect_b32 s50, 4294934528, s50
    s_cselect_b32 s43, -1, s43
    s_add_u32 s43, s43, 1
    v_mfma_f32_32x32x16_bf16 v[112:127], v[52:55], v[60:63], v[112:127]
L_p1_loop1_k2:
    s_waitcnt lgkmcnt(0)
    v_mfma_f32_32x32x16_bf16 v[64:79], v[32:35], v[40:43], v[64:79]
    ds_read_b128 v[48:51], v7
    ds_read_b128 v[52:55], v7 offset:4096
    v_lshlrev_b32 v14, 16, v40
    v_and_b32 v15, s45, v40
    v_add_f32 v12, v12, v14
    v_add_f32 v13, v13, v15
    v_mfma_f32_32x32x16_bf16 v[80:95], v[36:39], v[40:43], v[80:95]
    ds_read_b64_tr_b16 v[56:57], v9 offset:8192
    ds_read_b64_tr_b16 v[58:59], v9 offset:9216
    v_lshlrev_b32 v14, 16, v41
    v_and_b32 v15, s45, v41
    v_add_f32 v12, v12, v14
    v_add_f32 v13, v13, v15
    v_mfma_f32_32x32x16_bf16 v[96:111], v[32:35], v[44:47], v[96:111]
    ds_read_b64_tr_b16 v[60:61], v11 offset:8192
    ds_read_b64_tr_b16 v[62:63], v11 offset:9216
    v_lshlrev_b32 v14, 16, v42
    v_and_b32 v15, s45, v42
    v_add_f32 v12, v12, v14
    v_add_f32 v13, v13, v15
    v_mfma_f32_32x32x16_bf16 v[112:127], v[36:39], v[44:47], v[112:127]
    v_add_u32 v4, s49, v4
    v_add_u32 v8, s50, v8
    v_add_u32 v5, s49, v5
    v_add_u32 v9, s50, v9
    v_add_u32 v6, s49, v6
    v_add_u32 v10, s50, v10
    v_add_u32 v7, s49, v7
    v_add_u32 v11, s50, v11
    v_lshlrev_b32 v14, 16, v43
    v_and_b32 v15, s45, v43
    v_add_f32 v12, v12, v14
    v_add_f32 v13, v13, v15
    s_cmp_ge_u32 s40, 7
    s_cbranch_scc1 L_p1_loop1_tail
    s_waitcnt vmcnt(6) lgkmcnt(0)
    s_barrier
    v_mfma_f32_32x32x16_bf16 v[64:79], v[48:51], v[56:59], v[64:79]
    s_add_u32 m0, s60, 0
    ds_read_b128 v[32:35], v4
    buffer_load_dwordx4 v194, s[20:23], s51 offen lds
    s_add_u32 m0, s60, 8192
    ds_read_b128 v[36:39], v4 offset:4096
    buffer_load_dwordx4 v195, s[20:23], s51 offen lds
    v_mfma_f32_32x32x16_bf16 v[80:95], v[52:55], v[56:59], v[80:95]
    s_add_u32 m0, s60, 16384
    ds_read_b64_tr_b16 v[40:41], v8 offset:0
    buffer_load_dwordx4 v196, s[20:23], s51 offen lds
    s_add_u32 m0, s60, 24576
    ds_read_b64_tr_b16 v[42:43], v8 offset:1024
    buffer_load_dwordx4 v197, s[20:23], s51 offen lds
    v_mfma_f32_32x32x16_bf16 v[96:111], v[48:51], v[60:63], v[96:111]
    s_add_u32 m0, s61, 0
    ds_read_b64_tr_b16 v[44:45], v10 offset:0
    buffer_load_dwordx4 v198, s[24:27], s52 offen lds
    s_add_u32 m0, s61, 8192
    ds_read_b64_tr_b16 v[46:47], v10 offset:1024
    buffer_load_dwordx4 v199, s[24:27], s52 offen lds
    v_mfma_f32_32x32x16_bf16 v[112:127], v[52:55], v[60:63], v[112:127]
    s_add_u32 s40, s40, 1
    s_branch L_p1_loop1
L_p1_loop1_tail:
    s_cmp_ge_u32 s40, 9
    s_cbranch_scc1 L_p1_loop1_last
    s_cmp_ge_u32 s40, 8
    s_cbranch_scc1 L_p1_loop1_w0
    s_waitcnt vmcnt(6) lgkmcnt(0)
    s_barrier
    s_lshl_b32 s41, s33, 2
    v_mov_b32 v29, s41
    s_mov_b32 s42, 52429
    s_sub_u32 s3, s34, 10
    s_lshl_b32 s3, s3, 7
    s_lshl_b32 s41, s47, 6
    s_add_u32 s3, s3, s41
    v_mul_u32_u24 v24, 320, v193
    s_xor_b32 s41, s48, 0
    s_lshl_b32 s41, s41, 5
    s_add_u32 s41, s41, s3
    v_add_u32 v30, s41, v192
    v_mul_u32_u24 v31, s42, v30
    v_lshrrev_b32 v31, 20, v31
    v_mul_u32_u24 v25, 20, v31
    v_sub_u32 v25, v30, v25
    v_mul_u32_u24 v31, 81920, v31
    v_lshl_add_u32 v31, v25, 4, v31
    v_add_u32 v16, v31, v24
    s_xor_b32 s41, s48, 1
    s_lshl_b32 s41, s41, 5
    s_add_u32 s41, s41, s3
    v_add_u32 v30, s41, v192
    v_mul_u32_u24 v31, s42, v30
    v_lshrrev_b32 v31, 20, v31
    v_mul_u32_u24 v25, 20, v31
    v_sub_u32 v25, v30, v25
    v_mul_u32_u24 v31, 81920, v31
    v_lshl_add_u32 v31, v25, 4, v31
    v_add_u32 v17, v31, v24
    buffer_load_dword v28, v29, s[56:59], 0 offen sc1
    s_branch L_p1_loop1_go
L_p1_loop1_w0:
    s_waitcnt vmcnt(0) lgkmcnt(0)
    s_barrier
    s_mov_b32 s42, 0
L_p1_loop1_spin:
    v_readfirstlane_b32 s41, v28
    s_add_u32 s42, s42, 1
    s_cmp_ge_u32 s41, 5
    s_cbranch_scc1 L_p1_loop1_got
    s_cmp_ge_u32 s42, 0x40000
    s_cbranch_scc1 L_p1_loop1_got
    s_sleep 2
    buffer_load_dword v28, v29, s[56:59], 0 offen sc1
    s_waitcnt vmcnt(0)
    s_branch L_p1_loop1_spin
L_p1_loop1_got:
    s_lshl_b32 s41, s33, 10
    s_lshl_b32 s42, s46, 8
    s_add_u32 s41, s41, s42
    s_add_u32 s41, s41, 22183936
    s_add_u32 s42, s41, 8192
    s_lshl_b32 s41, s33, 10
    s_lshl_b32 s42, s47, 13
    s_add_u32 s41, s41, s42
    s_add_u32 s41, s41, 22183936
    v_and_b32 v30, 255, v0
    v_lshlrev_b32 v30, 2, v30
    buffer_load_dword v24, v30, s[28:31], s41 offen sc1
L_p1_loop1_go:
    v_mfma_f32_32x32x16_bf16 v[64:79], v[48:51], v[56:59], v[64:79]
    ds_read_b128 v[32:35], v4
    ds_read_b128 v[36:39], v4 offset:4096
    v_mfma_f32_32x32x16_bf16 v[80:95], v[52:55], v[56:59], v[80:95]
    ds_read_b64_tr_b16 v[40:41], v8 offset:0
    ds_read_b64_tr_b16 v[42:43], v8 offset:1024
    v_mfma_f32_32x32x16_bf16 v[96:111], v[48:51], v[60:63], v[96:111]
    ds_read_b64_tr_b16 v[44:45], v10 offset:0
    ds_read_b64_tr_b16 v[46:47], v10 offset:1024
    v_mfma_f32_32x32x16_bf16 v[112:127], v[52:55], v[60:63], v[112:127]
    s_add_u32 s40, s40, 1
    s_branch L_p1_loop1
L_p1_loop1_last:
    s_waitcnt lgkmcnt(0)
    v_mfma_f32_32x32x16_bf16 v[64:79], v[48:51], v[56:59], v[64:79]
    v_mfma_f32_32x32x16_bf16 v[80:95], v[52:55], v[56:59], v[80:95]
    v_mfma_f32_32x32x16_bf16 v[96:111], v[48:51], v[60:63], v[96:111]
    v_mfma_f32_32x32x16_bf16 v[112:127], v[52:55], v[60:63], v[112:127]
L_p1_stats:
    v_add_f32 v12, v12, v13
    v_mov_b32 v14, v12
    s_lshl_b32 s41, s47, 6
    s_lshl_b32 s42, s48, 5
    s_add_u32 s41, s41, s42
    v_mov_b32 v13, v12
    s_nop 1
    v_permlane32_swap_b32 v13, v14
    v_add_u32 v30, s41, v192
    v_lshlrev_b32 v30, 2, v30
    v_add_u32 v30, 147456, v30
    v_add_f32 v13, v13, v14
    s_mov_b64 exec, 0xffffffff
    ds_add_f32 v30, v13
    s_mov_b64 exec, -1
    s_lshl_b32 s41, s33, 3
    s_lshl_b32 s42, s46, 1
    s_add_u32 s40, s41, s42
    s_cmp_lt_u32 s34, 10
    s_cbranch_scc1 L_p1_nov
    s_cmp_ge_u32 s34, 15
    s_cbranch_scc1 L_p1_nov
    v_lshlrev_b32 v30, 2, v0
    v_add_u32 v30, 147968, v30
    s_waitcnt vmcnt(0)
    ds_write_b32 v30, v24
L_p1_nov:
    s_waitcnt lgkmcnt(0)
    s_barrier
    s_cmp_ge_u32 s34, 10
    s_cbranch_scc0 L_p1_epiT
    s_cmp_lt_u32 s34, 15
    s_cbranch_scc1 L_p1_epiV
L_p1_epiT:
    s_lshl_b32 s41, s47, 8
    v_lshlrev_b32 v30, 4, v193
    v_add_u32 v30, s41, v30
    v_add_u32 v30, 147456, v30
    s_lshl_b32 s41, s48, 7
    v_add_u32 v31, s41, v30
    s_xor_b32 s41, s41, 128
    v_add_u32 v30, s41, v30
    ds_read_b128 v[32:35], v31 offset:0
    ds_read_b128 v[36:39], v31 offset:32
    ds_read_b128 v[40:43], v31 offset:64
    ds_read_b128 v[44:47], v31 offset:96
    ds_read_b128 v[48:51], v30 offset:0
    ds_read_b128 v[52:55], v30 offset:32
    ds_read_b128 v[56:59], v30 offset:64
    ds_read_b128 v[60:63], v30 offset:96
    s_cmp_lt_u32 s34, 5
    s_cselect_b32 s45, 0x3ea52b5c, 1.0
    s_cselect_b32 s51, 0, 2621440
    s_cselect_b32 s3, 0, 5
    s_sub_u32 s3, s34, s3
    s_lshl_b32 s3, s3, 4
    s_lshl_b32 s41, s47, 3
    s_add_u32 s3, s3, s41
    s_mul_i32 s41, s40, 80
    s_add_u32 s3, s3, s41
    s_lshl_b32 s3, s3, 9
    s_add_u32 s51, s51, s3
    v_lshlrev_b32 v16, 4, v192
    v_lshl_add_u32 v16, v193, 9, v16
    s_waitcnt vmcnt(0)
    v_mul_f32 v24, s45, v24
    v_mul_f32 v25, s45, v25
    v_mul_f32 v26, s45, v26
    v_mul_f32 v27, s45, v27
    s_cmp_ge_u32 s34, 15
    s_cbranch_scc1 L_p1_epiH
    s_waitcnt lgkmcnt(0)
    s_xor_b32 s41, s48, 0
    s_lshl_b32 s41, s41, 11
    s_add_u32 s41, s41, s51
    v_pk_mul_f32 v[28:29], v[32:33], v[24:25] op_sel:[0,1] op_sel_hi:[1,1]
    v_pk_fma_f32 v[64:65], v[64:65], v[24:25], v[28:29] op_sel:[0,0,0] op_sel_hi:[1,0,1]
    v_pk_mul_f32 v[30:31], v[34:35], v[24:25] op_sel:[0,1] op_sel_hi:[1,1]
    v_pk_fma_f32 v[66:67], v[66:67], v[24:25], v[30:31] op_sel:[0,0,0] op_sel_hi:[1,0,1]
    v_pk_mul_f32 v[28:29], v[36:37], v[24:25] op_sel:[0,1] op_sel_hi:[1,1]
    v_pk_fma_f32 v[68:69], v[68:69], v[24:25], v[28:29] op_sel:[0,0,0] op_sel_hi:[1,0,1]
    v_pk_mul_f32 v[30:31], v[38:39], v[24:25] op_sel:[0,1] op_sel_hi:[1,1]
    v_pk_fma_f32 v[70:71], v[70:71], v[24:25], v[30:31] op_sel:[0,0,0] op_sel_hi:[1,0,1]
    v_cvt_pk_bf16_f32 v64, v64, v65
    v_cvt_pk_bf16_f32 v65, v66, v67
    v_cvt_pk_bf16_f32 v66, v68, v69
    v_cvt_pk_bf16_f32 v67, v70, v71
    s_nop 0
    v_permlane32_swap_b32 v64, v66
    v_permlane32_swap_b32 v65, v67
    buffer_store_dwordx4 v[64:67], v16, s[28:31], s41 offen offset:0 sc0 sc1
    v_pk_mul_f32 v[28:29], v[40:41], v[24:25] op_sel:[0,1] op_sel_hi:[1,1]
    v_pk_fma_f32 v[72:73], v[72:73], v[24:25], v[28:29] op_sel:[0,0,0] op_sel_hi:[1,0,1]
    v_pk_mul_f32 v[30:31], v[42:43], v[24:25] op_sel:[0,1] op_sel_hi:[1,1]
    v_pk_fma_f32 v[74:75], v[74:75], v[24:25], v[30:31] op_sel:[0,0,0] op_sel_hi:[1,0,1]
    v_pk_mul_f32 v[28:29], v[44:45], v[24:25] op_sel:[0,1] op_sel_hi:[1,1]
    v_pk_fma_f32 v[76:77], v[76:77], v[24:25], v[28:29] op_sel:[0,0,0] op_sel_hi:[1,0,1]
    v_pk_mul_f32 v[30:31], v[46:47], v[24:25] op_sel:[0,1] op_sel_hi:[1,1]
    v_pk_fma_f32 v[78:79], v[78:79], v[24:25], v[30:31] op_sel:[0,0,0] op_sel_hi:[1,0,1]
    v_cvt_pk_bf16_f32 v72, v72, v73
    v_cvt_pk_bf16_f32 v73, v74, v75
    v_cvt_pk_bf16_f32 v74, v76, v77
    v_cvt_pk_bf16_f32 v75, v78, v79
    s_nop 0
    v_permlane32_swap_b32 v72, v74
    v_permlane32_swap_b32 v73, v75
    buffer_store_dwordx4 v[72:75], v16, s[28:31], s41 offen offset:1024 sc0 sc1
    s_xor_b32 s41, s48, 0
    s_lshl_b32 s41, s41, 11
    s_add_u32 s41, s41, s51
    s_add_u32 s41, s41, 40960
    v_pk_mul_f32 v[28:29], v[32:33], v[26:27] op_sel:[0,1] op_sel_hi:[1,1]
    v_pk_fma_f32 v[80:81], v[80:81], v[26:27], v[28:29] op_sel:[0,0,0] op_sel_hi:[1,0,1]
    v_pk_mul_f32 v[30:31], v[34:35], v[26:27] op_sel:[0,1] op_sel_hi:[1,1]
    v_pk_fma_f32 v[82:83], v[82:83], v[26:27], v[30:31] op_sel:[0,0,0] op_sel_hi:[1,0,1]
    v_pk_mul_f32 v[28:29], v[36:37], v[26:27] op_sel:[0,1] op_sel_hi:[1,1]
    v_pk_fma_f32 v[84:85], v[84:85], v[26:27], v[28:29] op_sel:[0,0,0] op_sel_hi:[1,0,1]
    v_pk_mul_f32 v[30:31], v[38:39], v[26:27] op_sel:[0,1] op_sel_hi:[1,1]
    v_pk_fma_f32 v[86:87], v[86:87], v[26:27], v[30:31] op_sel:[0,0,0] op_sel_hi:[1,0,1]
    v_cvt_pk_bf16_f32 v80, v80, v81
    v_cvt_pk_bf16_f32 v81, v82, v83
    v_cvt_pk_bf16_f32 v82, v84, v85
    v_cvt_pk_bf16_f32 v83, v86, v87
    s_nop 0
    v_permlane32_swap_b32 v80, v82
    v_permlane32_swap_b32 v81, v83
    buffer_store_dwordx4 v[80:83], v16, s[28:31], s41 offen offset:0 sc0 sc1
    v_pk_mul_f32 v[28:29], v[40:41], v[26:27] op_sel:[0,1] op_sel_hi:[1,1]
    v_pk_fma_f32 v[88:89], v[88:89], v[26:27], v[28:29] op_sel:[0,0,0] op_sel_hi:[1,0,1]
    v_pk_mul_f32 v[30:31], v[42:43], v[26:27] op_sel:[0,1] op_sel_hi:[1,1]
    v_pk_fma_f32 v[90:91], v[90:91], v[26:27], v[30:31] op_sel:[0,0,0] op_sel_hi:[1,0,1]
    v_pk_mul_f32 v[28:29], v[44:45], v[26:27] op_sel:[0,1] op_sel_hi:[1,1]
    v_pk_fma_f32 v[92:93], v[92:93], v[26:27], v[28:29] op_sel:[0,0,0] op_sel_hi:[1,0,1]
    v_pk_mul_f32 v[30:31], v[46:47], v[26:27] op_sel:[0,1] op_sel_hi:[1,1]
    v_pk_fma_f32 v[94:95], v[94:95], v[26:27], v[30:31] op_sel:[0,0,0] op_sel_hi:[1,0,1]
    v_cvt_pk_bf16_f32 v88, v88, v89
    v_cvt_pk_bf16_f32 v89, v90, v91
    v_cvt_pk_bf16_f32 v90, v92, v93
    v_cvt_pk_bf16_f32 v91, v94, v95
    s_nop 0
    v_permlane32_swap_b32 v88, v90
    v_permlane32_swap_b32 v89, v91
    buffer_store_dwordx4 v[88:91], v16, s[28:31], s41 offen offset:1024 sc0 sc1
    s_xor_b32 s41, s48, 1
    s_lshl_b32 s41, s41, 11
    s_add_u32 s41, s41, s51
    v_pk_mul_f32 v[28:29], v[48:49], v[24:25] op_sel:[0,1] op_sel_hi:[1,1]
    v_pk_fma_f32 v[96:97], v[96:97], v[24:25], v[28:29] op_sel:[0,0,0] op_sel_hi:[1,0,1]
    v_pk_mul_f32 v[30:31], v[50:51], v[24:25] op_sel:[0,1] op_sel_hi:[1,1]
    v_pk_fma_f32 v[98:99], v[98:99], v[24:25], v[30:31] op_sel:[0,0,0] op_sel_hi:[1,0,1]
    v_pk_mul_f32 v[28:29], v[52:53], v[24:25] op_sel:[0,1] op_sel_hi:[1,1]
    v_pk_fma_f32 v[100:101], v[100:101], v[24:25], v[28:29] op_sel:[0,0,0] op_sel_hi:[1,0,1]
    v_pk_mul_f32 v[30:31], v[54:55], v[24:25] op_sel:[0,1] op_sel_hi:[1,1]
    v_pk_fma_f32 v[102:103], v[102:103], v[24:25], v[30:31] op_sel:[0,0,0] op_sel_hi:[1,0,1]
    v_cvt_pk_bf16_f32 v96, v96, v97
    v_cvt_pk_bf16_f32 v97, v98, v99
    v_cvt_pk_bf16_f32 v98, v100, v101
    v_cvt_pk_bf16_f32 v99, v102, v103
    s_nop 0
    v_permlane32_swap_b32 v96, v98
    v_permlane32_swap_b32 v97, v99
    buffer_store_dwordx4 v[96:99], v16, s[28:31], s41 offen offset:0 sc0 sc1
    v_pk_mul_f32 v[28:29], v[56:57], v[24:25] op_sel:[0,1] op_sel_hi:[1,1]
    v_pk_fma_f32 v[104:105], v[104:105], v[24:25], v[28:29] op_sel:[0,0,0] op_sel_hi:[1,0,1]
    v_pk_mul_f32 v[30:31], v[58:59], v[24:25] op_sel:[0,1] op_sel_hi:[1,1]
    v_pk_fma_f32 v[106:107], v[106:107], v[24:25], v[30:31] op_sel:[0,0,0] op_sel_hi:[1,0,1]
    v_pk_mul_f32 v[28:29], v[60:61], v[24:25] op_sel:[0,1] op_sel_hi:[1,1]
    v_pk_fma_f32 v[108:109], v[108:109], v[24:25], v[28:29] op_sel:[0,0,0] op_sel_hi:[1,0,1]
    v_pk_mul_f32 v[30:31], v[62:63], v[24:25] op_sel:[0,1] op_sel_hi:[1,1]
    v_pk_fma_f32 v[110:111], v[110:111], v[24:25], v[30:31] op_sel:[0,0,0] op_sel_hi:[1,0,1]
    v_cvt_pk_bf16_f32 v104, v104, v105
    v_cvt_pk_bf16_f32 v105, v106, v107
    v_cvt_pk_bf16_f32 v106, v108, v109
    v_cvt_pk_bf16_f32 v107, v110, v111
    s_nop 0
    v_permlane32_swap_b32 v104, v106
    v_permlane32_swap_b32 v105, v107
    buffer_store_dwordx4 v[104:107], v16, s[28:31], s41 offen offset:1024 sc0 sc1
    s_xor_b32 s41, s48, 1
    s_lshl_b32 s41, s41, 11
    s_add_u32 s41, s41, s51
    s_add_u32 s41, s41, 40960
    v_pk_mul_f32 v[28:29], v[48:49], v[26:27] op_sel:[0,1] op_sel_hi:[1,1]
    v_pk_fma_f32 v[112:113], v[112:113], v[26:27], v[28:29] op_sel:[0,0,0] op_sel_hi:[1,0,1]
    v_pk_mul_f32 v[30:31], v[50:51], v[26:27] op_sel:[0,1] op_sel_hi:[1,1]
    v_pk_fma_f32 v[114:115], v[114:115], v[26:27], v[30:31] op_sel:[0,0,0] op_sel_hi:[1,0,1]
    v_pk_mul_f32 v[28:29], v[52:53], v[26:27] op_sel:[0,1] op_sel_hi:[1,1]
    v_pk_fma_f32 v[116:117], v[116:117], v[26:27], v[28:29] op_sel:[0,0,0] op_sel_hi:[1,0,1]
    v_pk_mul_f32 v[30:31], v[54:55], v[26:27] op_sel:[0,1] op_sel_hi:[1,1]
    v_pk_fma_f32 v[118:119], v[118:119], v[26:27], v[30:31] op_sel:[0,0,0] op_sel_hi:[1,0,1]
    v_cvt_pk_bf16_f32 v112, v112, v113
    v_cvt_pk_bf16_f32 v113, v114, v115
    v_cvt_pk_bf16_f32 v114, v116, v117
    v_cvt_pk_bf16_f32 v115, v118, v119
    s_nop 0
    v_permlane32_swap_b32 v112, v114
    v_permlane32_swap_b32 v113, v115
    buffer_store_dwordx4 v[112:115], v16, s[28:31], s41 offen offset:0 sc0 sc1
    v_pk_mul_f32 v[28:29], v[56:57], v[26:27] op_sel:[0,1] op_sel_hi:[1,1]
    v_pk_fma_f32 v[120:121], v[120:121], v[26:27], v[28:29] op_sel:[0,0,0] op_sel_hi:[1,0,1]
    v_pk_mul_f32 v[30:31], v[58:59], v[26:27] op_sel:[0,1] op_sel_hi:[1,1]
    v_pk_fma_f32 v[122:123], v[122:123], v[26:27], v[30:31] op_sel:[0,0,0] op_sel_hi:[1,0,1]
    v_pk_mul_f32 v[28:29], v[60:61], v[26:27] op_sel:[0,1] op_sel_hi:[1,1]
    v_pk_fma_f32 v[124:125], v[124:125], v[26:27], v[28:29] op_sel:[0,0,0] op_sel_hi:[1,0,1]
    v_pk_mul_f32 v[30:31], v[62:63], v[26:27] op_sel:[0,1] op_sel_hi:[1,1]
    v_pk_fma_f32 v[126:127], v[126:127], v[26:27], v[30:31] op_sel:[0,0,0] op_sel_hi:[1,0,1]
    v_cvt_pk_bf16_f32 v120, v120, v121
    v_cvt_pk_bf16_f32 v121, v122, v123
    v_cvt_pk_bf16_f32 v122, v124, v125
    v_cvt_pk_bf16_f32 v123, v126, v127
    s_nop 0
    v_permlane32_swap_b32 v120, v122
    v_permlane32_swap_b32 v121, v123
    buffer_store_dwordx4 v[120:123], v16, s[28:31], s41 offen offset:1024 sc0 sc1
    s_branch L_p1_end
L_p1_epiH:
    s_mul_i32 s41, s40, 96
    s_sub_u32 s3, s34, 15
    s_lshl_b32 s3, s3, 3
    s_add_u32 s41, s41, s3
    s_lshl_b32 s3, s47, 2
    s_add_u32 s41, s41, s3
    s_lshl_b32 s41, s41, 10
    s_add_u32 s51, s41, 7864320
    v_lshlrev_b32 v4, 4, v1
    s_waitcnt lgkmcnt(0)
    s_xor_b32 s41, s48, 0
    s_lshl_b32 s41, s41, 11
    s_add_u32 s41, s41, s51
    s_add_u32 s41, s41, 0
    v_pk_mul_f32 v[28:29], v[32:33], v[24:25] op_sel:[0,1] op_sel_hi:[1,1]
    v_pk_fma_f32 v[64:65], v[64:65], v[24:25], v[28:29] op_sel:[0,0,0] op_sel_hi:[1,0,1]
    v_pk_mul_f32 v[30:31], v[34:35], v[24:25] op_sel:[0,1] op_sel_hi:[1,1]
    v_pk_fma_f32 v[66:67], v[66:67], v[24:25], v[30:31] op_sel:[0,0,0] op_sel_hi:[1,0,1]
    v_pk_mul_f32 v[28:29], v[36:37], v[24:25] op_sel:[0,1] op_sel_hi:[1,1]
    v_pk_fma_f32 v[68:69], v[68:69], v[24:25], v[28:29] op_sel:[0,0,0] op_sel_hi:[1,0,1]
    v_pk_mul_f32 v[30:31], v[38:39], v[24:25] op_sel:[0,1] op_sel_hi:[1,1]
    v_pk_fma_f32 v[70:71], v[70:71], v[24:25], v[30:31] op_sel:[0,0,0] op_sel_hi:[1,0,1]
    v_cvt_pk_bf16_f32 v64, v64, v65
    v_cvt_pk_bf16_f32 v65, v66, v67
    v_cvt_pk_bf16_f32 v66, v68, v69
    v_cvt_pk_bf16_f32 v67, v70, v71
    v_pk_max_i16 v64, v64, 0
    v_pk_max_i16 v65, v65, 0
    v_pk_max_i16 v66, v66, 0
    v_pk_max_i16 v67, v67, 0
    buffer_store_dwordx4 v[64:67], v4, s[28:31], s41 offen offset:0 sc0 sc1
    v_pk_mul_f32 v[28:29], v[40:41], v[24:25] op_sel:[0,1] op_sel_hi:[1,1]
    v_pk_fma_f32 v[72:73], v[72:73], v[24:25], v[28:29] op_sel:[0,0,0] op_sel_hi:[1,0,1]
    v_pk_mul_f32 v[30:31], v[42:43], v[24:25] op_sel:[0,1] op_sel_hi:[1,1]
    v_pk_fma_f32 v[74:75], v[74:75], v[24:25], v[30:31] op_sel:[0,0,0] op_sel_hi:[1,0,1]
    v_pk_mul_f32 v[28:29], v[44:45], v[24:25] op_sel:[0,1] op_sel_hi:[1,1]
    v_pk_fma_f32 v[76:77], v[76:77], v[24:25], v[28:29] op_sel:[0,0,0] op_sel_hi:[1,0,1]
    v_pk_mul_f32 v[30:31], v[46:47], v[24:25] op_sel:[0,1] op_sel_hi:[1,1]
    v_pk_fma_f32 v[78:79], v[78:79], v[24:25], v[30:31] op_sel:[0,0,0] op_sel_hi:[1,0,1]
    v_cvt_pk_bf16_f32 v72, v72, v73
    v_cvt_pk_bf16_f32 v73, v74, v75
    v_cvt_pk_bf16_f32 v74, v76, v77
    v_cvt_pk_bf16_f32 v75, v78, v79
    v_pk_max_i16 v72, v72, 0
    v_pk_max_i16 v73, v73, 0
    v_pk_max_i16 v74, v74, 0
    v_pk_max_i16 v75, v75, 0
    buffer_store_dwordx4 v[72:75], v4, s[28:31], s41 offen offset:1024 sc0 sc1
    s_xor_b32 s41, s48, 0
    s_lshl_b32 s41, s41, 11
    s_add_u32 s41, s41, s51
    s_add_u32 s41, s41, 98304
    v_pk_mul_f32 v[28:29], v[32:33], v[26:27] op_sel:[0,1] op_sel_hi:[1,1]
    v_pk_fma_f32 v[80:81], v[80:81], v[26:27], v[28:29] op_sel:[0,0,0] op_sel_hi:[1,0,1]
    v_pk_mul_f32 v[30:31], v[34:35], v[26:27] op_sel:[0,1] op_sel_hi:[1,1]
    v_pk_fma_f32 v[82:83], v[82:83], v[26:27], v[30:31] op_sel:[0,0,0] op_sel_hi:[1,0,1]
    v_pk_mul_f32 v[28:29], v[36:37], v[26:27] op_sel:[0,1] op_sel_hi:[1,1]
    v_pk_fma_f32 v[84:85], v[84:85], v[26:27], v[28:29] op_sel:[0,0,0] op_sel_hi:[1,0,1]
    v_pk_mul_f32 v[30:31], v[38:39], v[26:27] op_sel:[0,1] op_sel_hi:[1,1]
    v_pk_fma_f32 v[86:87], v[86:87], v[26:27], v[30:31] op_sel:[0,0,0] op_sel_hi:[1,0,1]
    v_cvt_pk_bf16_f32 v80, v80, v81
    v_cvt_pk_bf16_f32 v81, v82, v83
    v_cvt_pk_bf16_f32 v82, v84, v85
    v_cvt_pk_bf16_f32 v83, v86, v87
    v_pk_max_i16 v80, v80, 0
    v_pk_max_i16 v81, v81, 0
    v_pk_max_i16 v82, v82, 0
    v_pk_max_i16 v83, v83, 0
    buffer_store_dwordx4 v[80:83], v4, s[28:31], s41 offen offset:0 sc0 sc1
    v_pk_mul_f32 v[28:29], v[40:41], v[26:27] op_sel:[0,1] op_sel_hi:[1,1]
    v_pk_fma_f32 v[88:89], v[88:89], v[26:27], v[28:29] op_sel:[0,0,0] op_sel_hi:[1,0,1]
    v_pk_mul_f32 v[30:31], v[42:43], v[26:27] op_sel:[0,1] op_sel_hi:[1,1]
    v_pk_fma_f32 v[90:91], v[90:91], v[26:27], v[30:31] op_sel:[0,0,0] op_sel_hi:[1,0,1]
    v_pk_mul_f32 v[28:29], v[44:45], v[26:27] op_sel:[0,1] op_sel_hi:[1,1]
    v_pk_fma_f32 v[92:93], v[92:93], v[26:27], v[28:29] op_sel:[0,0,0] op_sel_hi:[1,0,1]
    v_pk_mul_f32 v[30:31], v[46:47], v[26:27] op_sel:[0,1] op_sel_hi:[1,1]
    v_pk_fma_f32 v[94:95], v[94:95], v[26:27], v[30:31] op_sel:[0,0,0] op_sel_hi:[1,0,1]
    v_cvt_pk_bf16_f32 v88, v88, v89
    v_cvt_pk_bf16_f32 v89, v90, v91
    v_cvt_pk_bf16_f32 v90, v92, v93
    v_cvt_pk_bf16_f32 v91, v94, v95
    v_pk_max_i16 v88, v88, 0
    v_pk_max_i16 v89, v89, 0
    v_pk_max_i16 v90, v90, 0
    v_pk_max_i16 v91, v91, 0
    buffer_store_dwordx4 v[88:91], v4, s[28:31], s41 offen offset:1024 sc0 sc1
    s_xor_b32 s41, s48, 1
    s_lshl_b32 s41, s41, 11
    s_add_u32 s41, s41, s51
    s_add_u32 s41, s41, 0
    v_pk_mul_f32 v[28:29], v[48:49], v[24:25] op_sel:[0,1] op_sel_hi:[1,1]
    v_pk_fma_f32 v[96:97], v[96:97], v[24:25], v[28:29] op_sel:[0,0,0] op_sel_hi:[1,0,1]
    v_pk_mul_f32 v[30:31], v[50:51], v[24:25] op_sel:[0,1] op_sel_hi:[1,1]
    v_pk_fma_f32 v[98:99], v[98:99], v[24:25], v[30:31] op_sel:[0,0,0] op_sel_hi:[1,0,1]
    v_pk_mul_f32 v[28:29], v[52:53], v[24:25] op_sel:[0,1] op_sel_hi:[1,1]
    v_pk_fma_f32 v[100:101], v[100:101], v[24:25], v[28:29] op_sel:[0,0,0] op_sel_hi:[1,0,1]
    v_pk_mul_f32 v[30:31], v[54:55], v[24:25] op_sel:[0,1] op_sel_hi:[1,1]
    v_pk_fma_f32 v[102:103], v[102:103], v[24:25], v[30:31] op_sel:[0,0,0] op_sel_hi:[1,0,1]
    v_cvt_pk_bf16_f32 v96, v96, v97
    v_cvt_pk_bf16_f32 v97, v98, v99
    v_cvt_pk_bf16_f32 v98, v100, v101
    v_cvt_pk_bf16_f32 v99, v102, v103
    v_pk_max_i16 v96, v96, 0
    v_pk_max_i16 v97, v97, 0
    v_pk_max_i16 v98, v98, 0
    v_pk_max_i16 v99, v99, 0
    buffer_store_dwordx4 v[96:99], v4, s[28:31], s41 offen offset:0 sc0 sc1
    v_pk_mul_f32 v[28:29], v[56:57], v[24:25] op_sel:[0,1] op_sel_hi:[1,1]
    v_pk_fma_f32 v[104:105], v[104:105], v[24:25], v[28:29] op_sel:[0,0,0] op_sel_hi:[1,0,1]
    v_pk_mul_f32 v[30:31], v[58:59], v[24:25] op_sel:[0,1] op_sel_hi:[1,1]
    v_pk_fma_f32 v[106:107], v[106:107], v[24:25], v[30:31] op_sel:[0,0,0] op_sel_hi:[1,0,1]
    v_pk_mul_f32 v[28:29], v[60:61], v[24:25] op_sel:[0,1] op_sel_hi:[1,1]
    v_pk_fma_f32 v[108:109], v[108:109], v[24:25], v[28:29] op_sel:[0,0,0] op_sel_hi:[1,0,1]
    v_pk_mul_f32 v[30:31], v[62:63], v[24:25] op_sel:[0,1] op_sel_hi:[1,1]
    v_pk_fma_f32 v[110:111], v[110:111], v[24:25], v[30:31] op_sel:[0,0,0] op_sel_hi:[1,0,1]
    v_cvt_pk_bf16_f32 v104, v104, v105
    v_cvt_pk_bf16_f32 v105, v106, v107
    v_cvt_pk_bf16_f32 v106, v108, v109
    v_cvt_pk_bf16_f32 v107, v110, v111
    v_pk_max_i16 v104, v104, 0
    v_pk_max_i16 v105, v105, 0
    v_pk_max_i16 v106, v106, 0
    v_pk_max_i16 v107, v107, 0
    buffer_store_dwordx4 v[104:107], v4, s[28:31], s41 offen offset:1024 sc0 sc1
    s_xor_b32 s41, s48, 1
    s_lshl_b32 s41, s41, 11
    s_add_u32 s41, s41, s51
    s_add_u32 s41, s41, 98304
    v_pk_mul_f32 v[28:29], v[48:49], v[26:27] op_sel:[0,1] op_sel_hi:[1,1]
    v_pk_fma_f32 v[112:113], v[112:113], v[26:27], v[28:29] op_sel:[0,0,0] op_sel_hi:[1,0,1]
    v_pk_mul_f32 v[30:31], v[50:51], v[26:27] op_sel:[0,1] op_sel_hi:[1,1]
    v_pk_fma_f32 v[114:115], v[114:115], v[26:27], v[30:31] op_sel:[0,0,0] op_sel_hi:[1,0,1]
    v_pk_mul_f32 v[28:29], v[52:53], v[26:27] op_sel:[0,1] op_sel_hi:[1,1]
    v_pk_fma_f32 v[116:117], v[116:117], v[26:27], v[28:29] op_sel:[0,0,0] op_sel_hi:[1,0,1]
    v_pk_mul_f32 v[30:31], v[54:55], v[26:27] op_sel:[0,1] op_sel_hi:[1,1]
    v_pk_fma_f32 v[118:119], v[118:119], v[26:27], v[30:31] op_sel:[0,0,0] op_sel_hi:[1,0,1]
    v_cvt_pk_bf16_f32 v112, v112, v113
    v_cvt_pk_bf16_f32 v113, v114, v115
    v_cvt_pk_bf16_f32 v114, v116, v117
    v_cvt_pk_bf16_f32 v115, v118, v119
    v_pk_max_i16 v112, v112, 0
    v_pk_max_i16 v113, v113, 0
    v_pk_max_i16 v114, v114, 0
    v_pk_max_i16 v115, v115, 0
    buffer_store_dwordx4 v[112:115], v4, s[28:31], s41 offen offset:0 sc0 sc1
    v_pk_mul_f32 v[28:29], v[56:57], v[26:27] op_sel:[0,1] op_sel_hi:[1,1]
    v_pk_fma_f32 v[120:121], v[120:121], v[26:27], v[28:29] op_sel:[0,0,0] op_sel_hi:[1,0,1]
    v_pk_mul_f32 v[30:31], v[58:59], v[26:27] op_sel:[0,1] op_sel_hi:[1,1]
    v_pk_fma_f32 v[122:123], v[122:123], v[26:27], v[30:31] op_sel:[0,0,0] op_sel_hi:[1,0,1]
    v_pk_mul_f32 v[28:29], v[60:61], v[26:27] op_sel:[0,1] op_sel_hi:[1,1]
    v_pk_fma_f32 v[124:125], v[124:125], v[26:27], v[28:29] op_sel:[0,0,0] op_sel_hi:[1,0,1]
    v_pk_mul_f32 v[30:31], v[62:63], v[26:27] op_sel:[0,1] op_sel_hi:[1,1]
    v_pk_fma_f32 v[126:127], v[126:127], v[26:27], v[30:31] op_sel:[0,0,0] op_sel_hi:[1,0,1]
    v_cvt_pk_bf16_f32 v120, v120, v121
    v_cvt_pk_bf16_f32 v121, v122, v123
    v_cvt_pk_bf16_f32 v122, v124, v125
    v_cvt_pk_bf16_f32 v123, v126, v127
    v_pk_max_i16 v120, v120, 0
    v_pk_max_i16 v121, v121, 0
    v_pk_max_i16 v122, v122, 0
    v_pk_max_i16 v123, v123, 0
    buffer_store_dwordx4 v[120:123], v4, s[28:31], s41 offen offset:1024 sc0 sc1
    s_branch L_p1_end
L_p1_epiV:
    s_lshl_b32 s41, s47, 6
    v_add_u32 v30, s41, v192
    v_lshlrev_b32 v30, 2, v30
    v_add_u32 v30, 147456, v30
    s_lshl_b32 s42, s48, 7
    v_add_u32 v31, s42, v30
    s_xor_b32 s42, s42, 128
    v_add_u32 v30, s42, v30
    ds_read_b32 v24, v31
    ds_read_b32 v26, v30
    s_mul_i32 s41, s40, 1280
    s_add_u32 s51, s41, 5242880
    s_lshl_b32 s41, s46, 8
    v_lshlrev_b32 v31, 4, v193
    v_add_u32 v31, s41, v31
    v_add_u32 v31, 147968, v31
    ds_read_b128 v[128:131], v31 offset:0
    ds_read_b128 v[144:147], v31 offset:1024
    ds_read_b128 v[132:135], v31 offset:32
    ds_read_b128 v[148:151], v31 offset:1056
    ds_read_b128 v[136:139], v31 offset:64
    ds_read_b128 v[152:155], v31 offset:1088
    ds_read_b128 v[140:143], v31 offset:96
    ds_read_b128 v[156:159], v31 offset:1120
    ds_read_b128 v[160:163], v31 offset:128
    ds_read_b128 v[176:179], v31 offset:1152
    ds_read_b128 v[164:167], v31 offset:160
    ds_read_b128 v[180:183], v31 offset:1184
    ds_read_b128 v[168:171], v31 offset:192
    ds_read_b128 v[184:187], v31 offset:1216
    ds_read_b128 v[172:175], v31 offset:224
    ds_read_b128 v[188:191], v31 offset:1248
    s_waitcnt vmcnt(0) lgkmcnt(0)
    v_pk_mul_f32 v[28:29], v[144:145], v[24:25] op_sel:[0,0] op_sel_hi:[1,0]
    v_pk_fma_f32 v[64:65], v[64:65], v[128:129], v[28:29]
    v_pk_mul_f32 v[30:31], v[146:147], v[24:25] op_sel:[0,0] op_sel_hi:[1,0]
    v_pk_fma_f32 v[66:67], v[66:67], v[130:131], v[30:31]
    v_pk_mul_f32 v[28:29], v[148:149], v[24:25] op_sel:[0,0] op_sel_hi:[1,0]
    v_pk_fma_f32 v[68:69], v[68:69], v[132:133], v[28:29]
    v_pk_mul_f32 v[30:31], v[150:151], v[24:25] op_sel:[0,0] op_sel_hi:[1,0]
    v_pk_fma_f32 v[70:71], v[70:71], v[134:135], v[30:31]
    v_pk_mul_f32 v[28:29], v[152:153], v[24:25] op_sel:[0,0] op_sel_hi:[1,0]
    v_pk_fma_f32 v[72:73], v[72:73], v[136:137], v[28:29]
    v_pk_mul_f32 v[30:31], v[154:155], v[24:25] op_sel:[0,0] op_sel_hi:[1,0]
    v_pk_fma_f32 v[74:75], v[74:75], v[138:139], v[30:31]
    v_pk_mul_f32 v[28:29], v[156:157], v[24:25] op_sel:[0,0] op_sel_hi:[1,0]
    v_pk_fma_f32 v[76:77], v[76:77], v[140:141], v[28:29]
    v_pk_mul_f32 v[30:31], v[158:159], v[24:25] op_sel:[0,0] op_sel_hi:[1,0]
    v_pk_fma_f32 v[78:79], v[78:79], v[142:143], v[30:31]
    v_cvt_pk_bf16_f32 v64, v64, v65
    v_cvt_pk_bf16_f32 v65, v66, v67
    v_cvt_pk_bf16_f32 v66, v68, v69
    v_cvt_pk_bf16_f32 v67, v70, v71
    v_cvt_pk_bf16_f32 v68, v72, v73
    v_cvt_pk_bf16_f32 v69, v74, v75
    v_cvt_pk_bf16_f32 v70, v76, v77
    v_cvt_pk_bf16_f32 v71, v78, v79
    buffer_store_dwordx4 v[64:67], v16, s[28:31], s51 offen sc0 sc1
    buffer_store_dwordx4 v[68:71], v16, s[28:31], s51 offen offset:640 sc0 sc1
    v_pk_mul_f32 v[28:29], v[144:145], v[26:27] op_sel:[0,0] op_sel_hi:[1,0]
    v_pk_fma_f32 v[96:97], v[96:97], v[128:129], v[28:29]
    v_pk_mul_f32 v[30:31], v[146:147], v[26:27] op_sel:[0,0] op_sel_hi:[1,0]
    v_pk_fma_f32 v[98:99], v[98:99], v[130:131], v[30:31]
    v_pk_mul_f32 v[28:29], v[148:149], v[26:27] op_sel:[0,0] op_sel_hi:[1,0]
    v_pk_fma_f32 v[100:101], v[100:101], v[132:133], v[28:29]
    v_pk_mul_f32 v[30:31], v[150:151], v[26:27] op_sel:[0,0] op_sel_hi:[1,0]
    v_pk_fma_f32 v[102:103], v[102:103], v[134:135], v[30:31]
    v_pk_mul_f32 v[28:29], v[152:153], v[26:27] op_sel:[0,0] op_sel_hi:[1,0]
    v_pk_fma_f32 v[104:105], v[104:105], v[136:137], v[28:29]
    v_pk_mul_f32 v[30:31], v[154:155], v[26:27] op_sel:[0,0] op_sel_hi:[1,0]
    v_pk_fma_f32 v[106:107], v[106:107], v[138:139], v[30:31]
    v_pk_mul_f32 v[28:29], v[156:157], v[26:27] op_sel:[0,0] op_sel_hi:[1,0]
    v_pk_fma_f32 v[108:109], v[108:109], v[140:141], v[28:29]
    v_pk_mul_f32 v[30:31], v[158:159], v[26:27] op_sel:[0,0] op_sel_hi:[1,0]
    v_pk_fma_f32 v[110:111], v[110:111], v[142:143], v[30:31]
    v_cvt_pk_bf16_f32 v96, v96, v97
    v_cvt_pk_bf16_f32 v97, v98, v99
    v_cvt_pk_bf16_f32 v98, v100, v101
    v_cvt_pk_bf16_f32 v99, v102, v103
    v_cvt_pk_bf16_f32 v100, v104, v105
    v_cvt_pk_bf16_f32 v101, v106, v107
    v_cvt_pk_bf16_f32 v102, v108, v109
    v_cvt_pk_bf16_f32 v103, v110, v111
    buffer_store_dwordx4 v[96:99], v17, s[28:31], s51 offen sc0 sc1
    buffer_store_dwordx4 v[100:103], v17, s[28:31], s51 offen offset:640 sc0 sc1
    s_add_u32 s51, s51, 1280
    v_pk_mul_f32 v[28:29], v[176:177], v[24:25] op_sel:[0,0] op_sel_hi:[1,0]
    v_pk_fma_f32 v[80:81], v[80:81], v[160:161], v[28:29]
    v_pk_mul_f32 v[30:31], v[178:179], v[24:25] op_sel:[0,0] op_sel_hi:[1,0]
    v_pk_fma_f32 v[82:83], v[82:83], v[162:163], v[30:31]
    v_pk_mul_f32 v[28:29], v[180:181], v[24:25] op_sel:[0,0] op_sel_hi:[1,0]
    v_pk_fma_f32 v[84:85], v[84:85], v[164:165], v[28:29]
    v_pk_mul_f32 v[30:31], v[182:183], v[24:25] op_sel:[0,0] op_sel_hi:[1,0]
    v_pk_fma_f32 v[86:87], v[86:87], v[166:167], v[30:31]
    v_pk_mul_f32 v[28:29], v[184:185], v[24:25] op_sel:[0,0] op_sel_hi:[1,0]
    v_pk_fma_f32 v[88:89], v[88:89], v[168:169], v[28:29]
    v_pk_mul_f32 v[30:31], v[186:187], v[24:25] op_sel:[0,0] op_sel_hi:[1,0]
    v_pk_fma_f32 v[90:91], v[90:91], v[170:171], v[30:31]
    v_pk_mul_f32 v[28:29], v[188:189], v[24:25] op_sel:[0,0] op_sel_hi:[1,0]
    v_pk_fma_f32 v[92:93], v[92:93], v[172:173], v[28:29]
    v_pk_mul_f32 v[30:31], v[190:191], v[24:25] op_sel:[0,0] op_sel_hi:[1,0]
    v_pk_fma_f32 v[94:95], v[94:95], v[174:175], v[30:31]
    v_cvt_pk_bf16_f32 v80, v80, v81
    v_cvt_pk_bf16_f32 v81, v82, v83
    v_cvt_pk_bf16_f32 v82, v84, v85
    v_cvt_pk_bf16_f32 v83, v86, v87
    v_cvt_pk_bf16_f32 v84, v88, v89
    v_cvt_pk_bf16_f32 v85, v90, v91
    v_cvt_pk_bf16_f32 v86, v92, v93
    v_cvt_pk_bf16_f32 v87, v94, v95
    buffer_store_dwordx4 v[80:83], v16, s[28:31], s51 offen sc0 sc1
    buffer_store_dwordx4 v[84:87], v16, s[28:31], s51 offen offset:640 sc0 sc1
    v_pk_mul_f32 v[28:29], v[176:177], v[26:27] op_sel:[0,0] op_sel_hi:[1,0]
    v_pk_fma_f32 v[112:113], v[112:113], v[160:161], v[28:29]
    v_pk_mul_f32 v[30:31], v[178:179], v[26:27] op_sel:[0,0] op_sel_hi:[1,0]
    v_pk_fma_f32 v[114:115], v[114:115], v[162:163], v[30:31]
    v_pk_mul_f32 v[28:29], v[180:181], v[26:27] op_sel:[0,0] op_sel_hi:[1,0]
    v_pk_fma_f32 v[116:117], v[116:117], v[164:165], v[28:29]
    v_pk_mul_f32 v[30:31], v[182:183], v[26:27] op_sel:[0,0] op_sel_hi:[1,0]
    v_pk_fma_f32 v[118:119], v[118:119], v[166:167], v[30:31]
    v_pk_mul_f32 v[28:29], v[184:185], v[26:27] op_sel:[0,0] op_sel_hi:[1,0]
    v_pk_fma_f32 v[120:121], v[120:121], v[168:169], v[28:29]
    v_pk_mul_f32 v[30:31], v[186:187], v[26:27] op_sel:[0,0] op_sel_hi:[1,0]
    v_pk_fma_f32 v[122:123], v[122:123], v[170:171], v[30:31]
    v_pk_mul_f32 v[28:29], v[188:189], v[26:27] op_sel:[0,0] op_sel_hi:[1,0]
    v_pk_fma_f32 v[124:125], v[124:125], v[172:173], v[28:29]
    v_pk_mul_f32 v[30:31], v[190:191], v[26:27] op_sel:[0,0] op_sel_hi:[1,0]
    v_pk_fma_f32 v[126:127], v[126:127], v[174:175], v[30:31]
    v_cvt_pk_bf16_f32 v112, v112, v113
    v_cvt_pk_bf16_f32 v113, v114, v115
    v_cvt_pk_bf16_f32 v114, v116, v117
    v_cvt_pk_bf16_f32 v115, v118, v119
    v_cvt_pk_bf16_f32 v116, v120, v121
    v_cvt_pk_bf16_f32 v117, v122, v123
    v_cvt_pk_bf16_f32 v118, v124, v125
    v_cvt_pk_bf16_f32 v119, v126, v127
    buffer_store_dwordx4 v[112:115], v17, s[28:31], s51 offen sc0 sc1
    buffer_store_dwordx4 v[116:119], v17, s[28:31], s51 offen offset:640 sc0 sc1
    s_branch L_p1_end
L_p1_spare:
    s_and_b32 s41, s2, 7
    s_lshr_b32 s42, s2, 3
    s_cmp_ge_u32 s42, 28
    s_cbranch_scc1 L_p1_sp1
    s_sub_u32 s41, s41, 6
    s_lshl_b32 s41, s41, 2
    s_add_u32 s41, s41, s42
    s_add_u32 s40, s41, 8
    s_branch L_p1_sp2
L_p1_sp1:
    s_lshl_b32 s41, s41, 2
    s_add_u32 s41, s41, s42
    s_sub_u32 s40, s41, 28
L_p1_sp2:
    v_mov_b32 v20, 0
    v_mov_b32 v21, 0
    v_mov_b32 v22, 0
    v_lshrrev_b32 v4, 4, v1
    v_and_b32 v5, 15, v1
    v_mul_u32_u24 v6, 1280, v4
    v_lshl_add_u32 v6, v5, 4, v6
    s_waitcnt lgkmcnt(0)
    s_mov_b32 s28, s16
    s_mov_b32 s29, s17
    s_mov_b32 s30, 23068672
    s_mov_b32 s31, 0x00020000
    s_mov_b32 s56, s18
    s_mov_b32 s57, s19
    s_mov_b32 s58, 256
    s_mov_b32 s59, 0x00020000
    s_and_b32 s3, s40, 3
    s_cmp_lg_u32 s3, 0
    s_cbranch_scc1 L_p1_nocpf
    s_cmp_ge_u32 s40, 32
    s_cbranch_scc1 L_p1_nocpf
    s_cmp_ge_u32 s32, 4
    s_cbranch_scc1 L_p1_nocpf
    s_getpc_b64 s[62:63]
L_pc_a:
    s_sub_u32 s62, s62, L_pc_a-recurrent_scan__softmax_full_mha__dense_activation_relu__prompt_kernel
    s_subb_u32 s63, s63, 0
    v_lshlrev_b32 v25, 7, v0
    v_min_u32 v25, CODE_END-recurrent_scan__softmax_full_mha__dense_activation_relu__prompt_kernel-4, v25
    v_mov_b32 v27, s63
    v_add_co_u32 v26, vcc, s62, v25
    s_nop 1
    v_addc_co_u32 v27, vcc, 0, v27, vcc
    global_load_dword v25, v[26:27], off
L_p1_nocpf:
    s_cmp_lg_u32 s40, 39
    s_cbranch_scc1 L_p1_noinit
    s_cmp_ge_u32 s32, 2
    s_cbranch_scc1 L_p1_init1
    v_lshlrev_b32 v7, 8, v0
    v_mov_b32 v8, 0
    s_mov_b32 s3, 22216704
    buffer_store_dword v8, v7, s[28:31], s3 offen sc0 sc1
    s_waitcnt vmcnt(0)
L_p1_init1:
    s_barrier
    s_cmp_lg_u32 s32, 0
    s_cbranch_scc1 L_p1_noinit
    v_lshlrev_b32 v7, 2, v1
    v_mov_b32 v8, 1
    s_mov_b64 exec, 0xff
    buffer_atomic_add v8, v7, s[56:59], 0 offen sc1
    s_mov_b64 exec, -1
L_p1_noinit:
    s_cmp_ge_u32 s40, 32
    s_cbranch_scc1 L_p1_relay
    s_mov_b32 s20, s4
    s_mov_b32 s21, s5
    s_mov_b32 s22, 2621440
    s_mov_b32 s23, 0x00020000
    s_lshl_b32 s41, s40, 6
    s_lshl_b32 s42, s32, 3
    s_add_u32 s41, s41, s42
    s_mul_i32 s51, s41, 1280
    s_add_u32 s52, s51, 5120
    s_and_b32 s3, s40, 3
    s_lshl_b32 s3, s3, 3
    s_add_u32 s3, s3, s32
    s_cmp_ge_u32 s3, 16
    s_cbranch_scc1 L_p1_pfw
    v_lshl_add_u32 v20, s3, 6, v1
    s_and_b32 s3, s2, 1
    s_lshl_b32 s3, s3, 10
    v_add_u32 v20, s3, v20
    v_mul_u32_u24 v20, 1280, v20
    v_add_u32 v20, 384, v20
    v_mov_b32 v22, 128
    v_mov_b32 v18, s4
    v_mov_b32 v21, s5
    s_branch L_p1_pfa
L_p1_pfw:
    s_sub_u32 s3, s3, 16
    s_min_u32 s3, s3, 13
    v_lshl_add_u32 v16, s3, 6, v1
    v_mul_u32_u24 v17, 4682, v16
    v_lshrrev_b32 v17, 16, v17
    v_mul_u32_u24 v18, 14, v17
    v_sub_u32 v16, v16, v18
    s_bfe_u32 s3, s2, 0x20001
    s_mul_i32 s3, s3, 14
    v_add_u32 v16, s3, v16
    v_min_u32 v16, 53, v16
    v_lshlrev_b32 v16, 7, v16
    v_add_u32 v17, 192, v17
    v_cmp_gt_u32 vcc, 3840, v16
    v_mul_u32_u24 v18, 3840, v17
    v_mul_u32_u24 v19, 3072, v17
    v_add_u32 v18, v18, v16
    v_add_u32 v19, v19, v16
    v_subrev_u32 v19, 3840, v19
    v_cndmask_b32 v20, v19, v18, vcc
    v_mov_b32 v18, s12
    v_mov_b32 v21, s13
    v_mov_b32 v16, s6
    v_mov_b32 v17, s7
    v_cndmask_b32 v18, v18, v16, vcc
    v_cndmask_b32 v21, v21, v17, vcc
    v_mov_b32 v22, 196608
    v_mov_b32 v16, 245760
    v_cndmask_b32 v22, v22, v16, vcc
L_p1_pfa:
    v_add_co_u32 v20, vcc, v18, v20
    s_nop 1
    v_addc_co_u32 v21, vcc, 0, v21, vcc
    global_load_dword v24, v[20:21], off
    v_add_co_u32 v20, vcc, v22, v20
    s_nop 1
    v_addc_co_u32 v21, vcc, 0, v21, vcc
    buffer_load_dwordx4 v[32:35], v6, s[20:23], s51 offen offset:0
    buffer_load_dwordx4 v[36:39], v6, s[20:23], s51 offen offset:256
    buffer_load_dwordx4 v[40:43], v6, s[20:23], s51 offen offset:512
    buffer_load_dwordx4 v[44:47], v6, s[20:23], s51 offen offset:768
    buffer_load_dwordx4 v[48:51], v6, s[20:23], s51 offen offset:1024
    buffer_load_dwordx4 v[52:55], v6, s[20:23], s52 offen offset:0
    buffer_load_dwordx4 v[56:59], v6, s[20:23], s52 offen offset:256
    buffer_load_dwordx4 v[60:63], v6, s[20:23], s52 offen offset:512
    buffer_load_dwordx4 v[64:67], v6, s[20:23], s52 offen offset:768
    buffer_load_dwordx4 v[68:71], v6, s[20:23], s52 offen offset:1024
    s_cmp_lt_u32 s40, 8
    s_cbranch_scc1 L_p1_noearly
    v_lshlrev_b32 v2, 4, v1
    s_lshl_b32 s38, s32, 10
    s_sub_u32 s3, s40, 8
    s_mul_i32 s37, s3, 81920
    s_mov_b32 s24, s14
    s_mov_b32 s25, s15
    s_mov_b32 s26, 1966080
    s_mov_b32 s27, 0x00020000
    s_add_u32 s3, s38, 0
    s_mov_b32 m0, s3
    s_add_u32 s3, s3, s37
    buffer_load_dwordx4 v2, s[24:27], s3 offen lds
    s_add_u32 s3, s38, 8192
    s_mov_b32 m0, s3
    s_add_u32 s3, s3, s37
    buffer_load_dwordx4 v2, s[24:27], s3 offen lds
    s_add_u32 s3, s38, 16384
    s_mov_b32 m0, s3
    s_add_u32 s3, s3, s37
    buffer_load_dwordx4 v2, s[24:27], s3 offen lds
    s_add_u32 s3, s38, 24576
    s_mov_b32 m0, s3
    s_add_u32 s3, s3, s37
    buffer_load_dwordx4 v2, s[24:27], s3 offen lds
    s_add_u32 s3, s38, 32768
    s_mov_b32 m0, s3
    s_add_u32 s3, s3, s37
    buffer_load_dwordx4 v2, s[24:27], s3 offen lds
    s_add_u32 s3, s38, 40960
    s_mov_b32 m0, s3
    s_add_u32 s3, s3, s37
    buffer_load_dwordx4 v2, s[24:27], s3 offen lds
    s_add_u32 s3, s38, 49152
    s_mov_b32 m0, s3
    s_add_u32 s3, s3, s37
    buffer_load_dwordx4 v2, s[24:27], s3 offen lds
    s_add_u32 s3, s38, 57344
    s_mov_b32 m0, s3
    s_add_u32 s3, s3, s37
    buffer_load_dwordx4 v2, s[24:27], s3 offen lds
    s_add_u32 s3, s38, 65536
    s_mov_b32 m0, s3
    s_add_u32 s3, s3, s37
    buffer_load_dwordx4 v2, s[24:27], s3 offen lds
    s_add_u32 s3, s38, 73728
    s_mov_b32 m0, s3
    s_add_u32 s3, s3, s37
    buffer_load_dwordx4 v2, s[24:27], s3 offen lds
    s_waitcnt vmcnt(10)
    s_branch L_p1_early1
L_p1_noearly:
    s_waitcnt vmcnt(0)
L_p1_early1:
    v_mov_b32 v8, 0
    v_mov_b32 v9, 0
    v_mov_b32 v10, 0
    v_mov_b32 v11, 0
    v_lshlrev_b32 v16, 16, v32
    v_and_b32 v17, 0xffff0000, v32
    v_pk_add_f32 v[8:9], v[8:9], v[16:17]
    v_pk_fma_f32 v[10:11], v[16:17], v[16:17], v[10:11]
    v_lshlrev_b32 v18, 16, v33
    v_and_b32 v19, 0xffff0000, v33
    v_pk_add_f32 v[8:9], v[8:9], v[18:19]
    v_pk_fma_f32 v[10:11], v[18:19], v[18:19], v[10:11]
    v_lshlrev_b32 v16, 16, v34
    v_and_b32 v17, 0xffff0000, v34
    v_pk_add_f32 v[8:9], v[8:9], v[16:17]
    v_pk_fma_f32 v[10:11], v[16:17], v[16:17], v[10:11]
    v_lshlrev_b32 v18, 16, v35
    v_and_b32 v19, 0xffff0000, v35
    v_pk_add_f32 v[8:9], v[8:9], v[18:19]
    v_pk_fma_f32 v[10:11], v[18:19], v[18:19], v[10:11]
    v_lshlrev_b32 v16, 16, v36
    v_and_b32 v17, 0xffff0000, v36
    v_pk_add_f32 v[8:9], v[8:9], v[16:17]
    v_pk_fma_f32 v[10:11], v[16:17], v[16:17], v[10:11]
    v_lshlrev_b32 v18, 16, v37
    v_and_b32 v19, 0xffff0000, v37
    v_pk_add_f32 v[8:9], v[8:9], v[18:19]
    v_pk_fma_f32 v[10:11], v[18:19], v[18:19], v[10:11]
    v_lshlrev_b32 v16, 16, v38
    v_and_b32 v17, 0xffff0000, v38
    v_pk_add_f32 v[8:9], v[8:9], v[16:17]
    v_pk_fma_f32 v[10:11], v[16:17], v[16:17], v[10:11]
    v_lshlrev_b32 v18, 16, v39
    v_and_b32 v19, 0xffff0000, v39
    v_pk_add_f32 v[8:9], v[8:9], v[18:19]
    v_pk_fma_f32 v[10:11], v[18:19], v[18:19], v[10:11]
    v_lshlrev_b32 v16, 16, v40
    v_and_b32 v17, 0xffff0000, v40
    v_pk_add_f32 v[8:9], v[8:9], v[16:17]
    v_pk_fma_f32 v[10:11], v[16:17], v[16:17], v[10:11]
    v_lshlrev_b32 v18, 16, v41
    v_and_b32 v19, 0xffff0000, v41
    v_pk_add_f32 v[8:9], v[8:9], v[18:19]
    v_pk_fma_f32 v[10:11], v[18:19], v[18:19], v[10:11]
    v_lshlrev_b32 v16, 16, v42
    v_and_b32 v17, 0xffff0000, v42
    v_pk_add_f32 v[8:9], v[8:9], v[16:17]
    v_pk_fma_f32 v[10:11], v[16:17], v[16:17], v[10:11]
    v_lshlrev_b32 v18, 16, v43
    v_and_b32 v19, 0xffff0000, v43
    v_pk_add_f32 v[8:9], v[8:9], v[18:19]
    v_pk_fma_f32 v[10:11], v[18:19], v[18:19], v[10:11]
    v_lshlrev_b32 v16, 16, v44
    v_and_b32 v17, 0xffff0000, v44
    v_pk_add_f32 v[8:9], v[8:9], v[16:17]
    v_pk_fma_f32 v[10:11], v[16:17], v[16:17], v[10:11]
    v_lshlrev_b32 v18, 16, v45
    v_and_b32 v19, 0xffff0000, v45
    v_pk_add_f32 v[8:9], v[8:9], v[18:19]
    v_pk_fma_f32 v[10:11], v[18:19], v[18:19], v[10:11]
    v_lshlrev_b32 v16, 16, v46
    v_and_b32 v17, 0xffff0000, v46
    v_pk_add_f32 v[8:9], v[8:9], v[16:17]
    v_pk_fma_f32 v[10:11], v[16:17], v[16:17], v[10:11]
    v_lshlrev_b32 v18, 16, v47
    v_and_b32 v19, 0xffff0000, v47
    v_pk_add_f32 v[8:9], v[8:9], v[18:19]
    v_pk_fma_f32 v[10:11], v[18:19], v[18:19], v[10:11]
    v_lshlrev_b32 v16, 16, v48
    v_and_b32 v17, 0xffff0000, v48
    v_pk_add_f32 v[8:9], v[8:9], v[16:17]
    v_pk_fma_f32 v[10:11], v[16:17], v[16:17], v[10:11]
    v_lshlrev_b32 v18, 16, v49
    v_and_b32 v19, 0xffff0000, v49
    v_pk_add_f32 v[8:9], v[8:9], v[18:19]
    v_pk_fma_f32 v[10:11], v[18:19], v[18:19], v[10:11]
    v_lshlrev_b32 v16, 16, v50
    v_and_b32 v17, 0xffff0000, v50
    v_pk_add_f32 v[8:9], v[8:9], v[16:17]
    v_pk_fma_f32 v[10:11], v[16:17], v[16:17], v[10:11]
    v_lshlrev_b32 v18, 16, v51
    v_and_b32 v19, 0xffff0000, v51
    v_pk_add_f32 v[8:9], v[8:9], v[18:19]
    v_pk_fma_f32 v[10:11], v[18:19], v[18:19], v[10:11]
    v_add_f32 v8, v8, v9
    v_add_f32 v10, v10, v11
    v_mov_b32 v12, 0
    v_mov_b32 v13, 0
    v_mov_b32 v14, 0
    v_mov_b32 v15, 0
    v_lshlrev_b32 v16, 16, v52
    v_and_b32 v17, 0xffff0000, v52
    v_pk_add_f32 v[12:13], v[12:13], v[16:17]
    v_pk_fma_f32 v[14:15], v[16:17], v[16:17], v[14:15]
    v_lshlrev_b32 v18, 16, v53
    v_and_b32 v19, 0xffff0000, v53
    v_pk_add_f32 v[12:13], v[12:13], v[18:19]
    v_pk_fma_f32 v[14:15], v[18:19], v[18:19], v[14:15]
    v_lshlrev_b32 v16, 16, v54
    v_and_b32 v17, 0xffff0000, v54
    v_pk_add_f32 v[12:13], v[12:13], v[16:17]
    v_pk_fma_f32 v[14:15], v[16:17], v[16:17], v[14:15]
    v_lshlrev_b32 v18, 16, v55
    v_and_b32 v19, 0xffff0000, v55
    v_pk_add_f32 v[12:13], v[12:13], v[18:19]
    v_pk_fma_f32 v[14:15], v[18:19], v[18:19], v[14:15]
    v_lshlrev_b32 v16, 16, v56
    v_and_b32 v17, 0xffff0000, v56
    v_pk_add_f32 v[12:13], v[12:13], v[16:17]
    v_pk_fma_f32 v[14:15], v[16:17], v[16:17], v[14:15]
    v_lshlrev_b32 v18, 16, v57
    v_and_b32 v19, 0xffff0000, v57
    v_pk_add_f32 v[12:13], v[12:13], v[18:19]
    v_pk_fma_f32 v[14:15], v[18:19], v[18:19], v[14:15]
    v_lshlrev_b32 v16, 16, v58
    v_and_b32 v17, 0xffff0000, v58
    v_pk_add_f32 v[12:13], v[12:13], v[16:17]
    v_pk_fma_f32 v[14:15], v[16:17], v[16:17], v[14:15]
    v_lshlrev_b32 v18, 16, v59
    v_and_b32 v19, 0xffff0000, v59
    v_pk_add_f32 v[12:13], v[12:13], v[18:19]
    v_pk_fma_f32 v[14:15], v[18:19], v[18:19], v[14:15]
    v_lshlrev_b32 v16, 16, v60
    v_and_b32 v17, 0xffff0000, v60
    v_pk_add_f32 v[12:13], v[12:13], v[16:17]
    v_pk_fma_f32 v[14:15], v[16:17], v[16:17], v[14:15]
    v_lshlrev_b32 v18, 16, v61
    v_and_b32 v19, 0xffff0000, v61
    v_pk_add_f32 v[12:13], v[12:13], v[18:19]
    v_pk_fma_f32 v[14:15], v[18:19], v[18:19], v[14:15]
    v_lshlrev_b32 v16, 16, v62
    v_and_b32 v17, 0xffff0000, v62
    v_pk_add_f32 v[12:13], v[12:13], v[16:17]
    v_pk_fma_f32 v[14:15], v[16:17], v[16:17], v[14:15]
    v_lshlrev_b32 v18, 16, v63
    v_and_b32 v19, 0xffff0000, v63
    v_pk_add_f32 v[12:13], v[12:13], v[18:19]
    v_pk_fma_f32 v[14:15], v[18:19], v[18:19], v[14:15]
    v_lshlrev_b32 v16, 16, v64
    v_and_b32 v17, 0xffff0000, v64
    v_pk_add_f32 v[12:13], v[12:13], v[16:17]
    v_pk_fma_f32 v[14:15], v[16:17], v[16:17], v[14:15]
    v_lshlrev_b32 v18, 16, v65
    v_and_b32 v19, 0xffff0000, v65
    v_pk_add_f32 v[12:13], v[12:13], v[18:19]
    v_pk_fma_f32 v[14:15], v[18:19], v[18:19], v[14:15]
    v_lshlrev_b32 v16, 16, v66
    v_and_b32 v17, 0xffff0000, v66
    v_pk_add_f32 v[12:13], v[12:13], v[16:17]
    v_pk_fma_f32 v[14:15], v[16:17], v[16:17], v[14:15]
    v_lshlrev_b32 v18, 16, v67
    v_and_b32 v19, 0xffff0000, v67
    v_pk_add_f32 v[12:13], v[12:13], v[18:19]
    v_pk_fma_f32 v[14:15], v[18:19], v[18:19], v[14:15]
    v_lshlrev_b32 v16, 16, v68
    v_and_b32 v17, 0xffff0000, v68
    v_pk_add_f32 v[12:13], v[12:13], v[16:17]
    v_pk_fma_f32 v[14:15], v[16:17], v[16:17], v[14:15]
    v_lshlrev_b32 v18, 16, v69
    v_and_b32 v19, 0xffff0000, v69
    v_pk_add_f32 v[12:13], v[12:13], v[18:19]
    v_pk_fma_f32 v[14:15], v[18:19], v[18:19], v[14:15]
    v_lshlrev_b32 v16, 16, v70
    v_and_b32 v17, 0xffff0000, v70
    v_pk_add_f32 v[12:13], v[12:13], v[16:17]
    v_pk_fma_f32 v[14:15], v[16:17], v[16:17], v[14:15]
    v_lshlrev_b32 v18, 16, v71
    v_and_b32 v19, 0xffff0000, v71
    v_pk_add_f32 v[12:13], v[12:13], v[18:19]
    v_pk_fma_f32 v[14:15], v[18:19], v[18:19], v[14:15]
    v_add_f32 v12, v12, v13
    v_add_f32 v14, v14, v15
    s_nop 1
    v_add_f32_dpp v8, v8, v8 row_ror:8 row_mask:0xf bank_mask:0xf
    v_add_f32_dpp v10, v10, v10 row_ror:8 row_mask:0xf bank_mask:0xf
    v_add_f32_dpp v12, v12, v12 row_ror:8 row_mask:0xf bank_mask:0xf
    v_add_f32_dpp v14, v14, v14 row_ror:8 row_mask:0xf bank_mask:0xf
    s_nop 1
    v_add_f32_dpp v8, v8, v8 row_ror:4 row_mask:0xf bank_mask:0xf
    v_add_f32_dpp v10, v10, v10 row_ror:4 row_mask:0xf bank_mask:0xf
    v_add_f32_dpp v12, v12, v12 row_ror:4 row_mask:0xf bank_mask:0xf
    v_add_f32_dpp v14, v14, v14 row_ror:4 row_mask:0xf bank_mask:0xf
    s_nop 1
    v_add_f32_dpp v8, v8, v8 row_ror:2 row_mask:0xf bank_mask:0xf
    v_add_f32_dpp v10, v10, v10 row_ror:2 row_mask:0xf bank_mask:0xf
    v_add_f32_dpp v12, v12, v12 row_ror:2 row_mask:0xf bank_mask:0xf
    v_add_f32_dpp v14, v14, v14 row_ror:2 row_mask:0xf bank_mask:0xf
    s_nop 1
    v_add_f32_dpp v8, v8, v8 row_ror:1 row_mask:0xf bank_mask:0xf
    v_add_f32_dpp v10, v10, v10 row_ror:1 row_mask:0xf bank_mask:0xf
    v_add_f32_dpp v12, v12, v12 row_ror:1 row_mask:0xf bank_mask:0xf
    v_add_f32_dpp v14, v14, v14 row_ror:1 row_mask:0xf bank_mask:0xf
    s_mov_b32 s42, 0x3acccccd
    v_mul_f32 v8, s42, v8
    v_mul_f32 v10, s42, v10
    v_fma_f32 v10, -v8, v8, v10
    v_max_f32 v10, 0, v10
    v_add_f32 v10, 0x3727c5ac, v10
    v_rsq_f32 v10, v10
    s_nop 0
    v_mul_f32 v8, v8, v10
    v_sub_f32 v8, 0, v8
    v_mul_f32 v12, s42, v12
    v_mul_f32 v14, s42, v14
    v_fma_f32 v14, -v12, v12, v14
    v_max_f32 v14, 0, v14
    v_add_f32 v14, 0x3727c5ac, v14
    v_rsq_f32 v14, v14
    s_nop 0
    v_mul_f32 v12, v12, v14
    v_sub_f32 v12, 0, v12
    v_lshlrev_b32 v7, 2, v4
    s_lshl_b32 s41, s41, 2
    s_add_u32 s41, s41, 22183936
    s_add_u32 s42, s41, 8192
    s_mov_b32 s60, 0x00010001
    s_mov_b32 s61, 0x00010001
    s_mov_b64 exec, s[60:61]
    buffer_store_dword v10, v7, s[28:31], s41 offen sc0 sc1
    buffer_store_dword v8, v7, s[28:31], s42 offen sc0 sc1
    buffer_store_dword v14, v7, s[28:31], s41 offen offset:16 sc0 sc1
    buffer_store_dword v12, v7, s[28:31], s42 offen offset:16 sc0 sc1
    s_mov_b64 exec, -1
    s_waitcnt vmcnt(0)
    s_barrier
    s_cmp_lg_u32 s32, 0
    s_cbranch_scc1 L_p1_relay
    s_lshr_b32 s41, s40, 2
    s_lshl_b32 s41, s41, 2
    v_mov_b32 v7, s41
    v_mov_b32 v8, 1
    s_mov_b64 exec, 1
    buffer_atomic_add v8, v7, s[56:59], 0 offen sc1
    s_mov_b64 exec, -1
L_p1_relay:
    s_cmp_ge_u32 s40, 8
    s_cbranch_scc1 L_p1_rjob
    global_load_dword v24, v[20:21], off
    v_add_co_u32 v20, vcc, v22, v20
    s_nop 1
    v_addc_co_u32 v21, vcc, 0, v21, vcc
    global_load_dword v24, v[20:21], off
    v_add_co_u32 v20, vcc, v22, v20
    s_nop 1
    v_addc_co_u32 v21, vcc, 0, v21, vcc
    global_load_dword v24, v[20:21], off
    v_add_co_u32 v20, vcc, v22, v20
    s_nop 1
    v_addc_co_u32 v21, vcc, 0, v21, vcc
    global_load_dword v24, v[20:21], off
    v_add_co_u32 v20, vcc, v22, v20
    s_nop 1
    v_addc_co_u32 v21, vcc, 0, v21, vcc
    global_load_dword v24, v[20:21], off
    v_add_co_u32 v20, vcc, v22, v20
    s_nop 1
    v_addc_co_u32 v21, vcc, 0, v21, vcc
    global_load_dword v24, v[20:21], off
    v_add_co_u32 v20, vcc, v22, v20
    s_nop 1
    v_addc_co_u32 v21, vcc, 0, v21, vcc
    s_branch L_p1_sdone
L_p1_rjob:
    s_sub_u32 s40, s40, 8
    v_lshlrev_b32 v2, 4, v1
    v_lshrrev_b32 v10, 5, v1
    v_and_b32 v5, 15, v1
    v_lshrrev_b32 v6, 2, v5
    v_and_b32 v5, 3, v5
    v_lshlrev_b32 v5, 3, v5
    v_bfe_u32 v11, v1, 4, 1
    v_lshl_add_u32 v11, v11, 5, v5
    s_lshl_b32 s42, s32, 10
    s_cmp_ge_u32 s40, 24
    s_cbranch_scc1 L_p1_rwo
    global_load_dword v24, v[20:21], off
    v_add_co_u32 v20, vcc, v22, v20
    s_nop 1
    v_addc_co_u32 v21, vcc, 0, v21, vcc
    global_load_dword v24, v[20:21], off
    v_add_co_u32 v20, vcc, v22, v20
    s_nop 1
    v_addc_co_u32 v21, vcc, 0, v21, vcc
    global_load_dword v24, v[20:21], off
    v_add_co_u32 v20, vcc, v22, v20
    s_nop 1
    v_addc_co_u32 v21, vcc, 0, v21, vcc
    global_load_dword v24, v[20:21], off
    v_add_co_u32 v20, vcc, v22, v20
    s_nop 1
    v_addc_co_u32 v21, vcc, 0, v21, vcc
    global_load_dword v24, v[20:21], off
    v_add_co_u32 v20, vcc, v22, v20
    s_nop 1
    v_addc_co_u32 v21, vcc, 0, v21, vcc
    global_load_dword v24, v[20:21], off
    v_add_co_u32 v20, vcc, v22, v20
    s_nop 1
    v_addc_co_u32 v21, vcc, 0, v21, vcc
    v_lshl_add_u32 v4, v10, 2, v6
    v_mul_u32_u24 v4, 1280, v4
    v_add_u32 v4, v4, v11
    s_lshr_b32 s41, s32, 1
    s_mul_i32 s42, s41, 20480
    s_and_b32 s48, s32, 1
    s_mul_i32 s48, s48, 10
    s_lshl_b32 s35, s48, 6
    s_add_u32 s42, s42, s35
    v_add_u32 v4, s42, v4
    v_add_u32 v5, 10240, v4
    s_lshl_b32 s3, s40, 2
    s_add_u32 s3, s3, s41
    s_mul_i32 s3, s3, 20
    s_add_u32 s3, s3, s48
    s_lshl_b32 s3, s3, 10
    s_add_u32 s51, s3, 14155776
    s_nop 0
    s_nop 0
    ds_read_b64_tr_b16 v[32:33], v4 offset:0
    ds_read_b64_tr_b16 v[34:35], v5 offset:0
    ds_read_b64_tr_b16 v[36:37], v4 offset:64
    ds_read_b64_tr_b16 v[38:39], v5 offset:64
    ds_read_b64_tr_b16 v[40:41], v4 offset:128
    ds_read_b64_tr_b16 v[42:43], v5 offset:128
    ds_read_b64_tr_b16 v[44:45], v4 offset:192
    ds_read_b64_tr_b16 v[46:47], v5 offset:192
    ds_read_b64_tr_b16 v[48:49], v4 offset:256
    ds_read_b64_tr_b16 v[50:51], v5 offset:256
    ds_read_b64_tr_b16 v[52:53], v4 offset:320
    ds_read_b64_tr_b16 v[54:55], v5 offset:320
    ds_read_b64_tr_b16 v[56:57], v4 offset:384
    ds_read_b64_tr_b16 v[58:59], v5 offset:384
    ds_read_b64_tr_b16 v[60:61], v4 offset:448
    ds_read_b64_tr_b16 v[62:63], v5 offset:448
    ds_read_b64_tr_b16 v[64:65], v4 offset:512
    ds_read_b64_tr_b16 v[66:67], v5 offset:512
    ds_read_b64_tr_b16 v[68:69], v4 offset:576
    ds_read_b64_tr_b16 v[70:71], v5 offset:576
    s_waitcnt lgkmcnt(0)
    buffer_store_dwordx4 v[32:35], v2, s[28:31], s51 offen sc0 sc1
    s_add_u32 s51, s51, 1024
    buffer_store_dwordx4 v[36:39], v2, s[28:31], s51 offen sc0 sc1
    s_add_u32 s51, s51, 1024
    buffer_store_dwordx4 v[40:43], v2, s[28:31], s51 offen sc0 sc1
    s_add_u32 s51, s51, 1024
    buffer_store_dwordx4 v[44:47], v2, s[28:31], s51 offen sc0 sc1
    s_add_u32 s51, s51, 1024
    buffer_store_dwordx4 v[48:51], v2, s[28:31], s51 offen sc0 sc1
    s_add_u32 s51, s51, 1024
    buffer_store_dwordx4 v[52:55], v2, s[28:31], s51 offen sc0 sc1
    s_add_u32 s51, s51, 1024
    buffer_store_dwordx4 v[56:59], v2, s[28:31], s51 offen sc0 sc1
    s_add_u32 s51, s51, 1024
    buffer_store_dwordx4 v[60:63], v2, s[28:31], s51 offen sc0 sc1
    s_add_u32 s51, s51, 1024
    buffer_store_dwordx4 v[64:67], v2, s[28:31], s51 offen sc0 sc1
    s_add_u32 s51, s51, 1024
    buffer_store_dwordx4 v[68:71], v2, s[28:31], s51 offen sc0 sc1
    s_branch L_p1_rdone
L_p1_rwo:
    s_mov_b32 s20, s8
    s_mov_b32 s21, s9
    s_mov_b32 s22, 819200
    s_mov_b32 s23, 0x00020000
    s_sub_u32 s40, s40, 24
    s_mul_i32 s52, s40, 102400
    s_add_u32 s41, s42, 0
    s_mov_b32 m0, s41
    s_add_u32 s41, s41, s52
    buffer_load_dwordx4 v2, s[20:23], s41 offen lds
    s_add_u32 s41, s42, 8192
    s_mov_b32 m0, s41
    s_add_u32 s41, s41, s52
    buffer_load_dwordx4 v2, s[20:23], s41 offen lds
    s_add_u32 s41, s42, 16384
    s_mov_b32 m0, s41
    s_add_u32 s41, s41, s52
    buffer_load_dwordx4 v2, s[20:23], s41 offen lds
    s_add_u32 s41, s42, 24576
    s_mov_b32 m0, s41
    s_add_u32 s41, s41, s52
    buffer_load_dwordx4 v2, s[20:23], s41 offen lds
    s_add_u32 s41, s42, 32768
    s_mov_b32 m0, s41
    s_add_u32 s41, s41, s52
    buffer_load_dwordx4 v2, s[20:23], s41 offen lds
    s_add_u32 s41, s42, 40960
    s_mov_b32 m0, s41
    s_add_u32 s41, s41, s52
    buffer_load_dwordx4 v2, s[20:23], s41 offen lds
    s_add_u32 s41, s42, 49152
    s_mov_b32 m0, s41
    s_add_u32 s41, s41, s52
    buffer_load_dwordx4 v2, s[20:23], s41 offen lds
    s_add_u32 s41, s42, 57344
    s_mov_b32 m0, s41
    s_add_u32 s41, s41, s52
    buffer_load_dwordx4 v2, s[20:23], s41 offen lds
    s_add_u32 s41, s42, 65536
    s_mov_b32 m0, s41
    s_add_u32 s41, s41, s52
    buffer_load_dwordx4 v2, s[20:23], s41 offen lds
    s_add_u32 s41, s42, 73728
    s_mov_b32 m0, s41
    s_add_u32 s41, s41, s52
    buffer_load_dwordx4 v2, s[20:23], s41 offen lds
    s_add_u32 s41, s42, 81920
    s_mov_b32 m0, s41
    s_add_u32 s41, s41, s52
    buffer_load_dwordx4 v2, s[20:23], s41 offen lds
    s_add_u32 s41, s42, 90112
    s_mov_b32 m0, s41
    s_add_u32 s41, s41, s52
    buffer_load_dwordx4 v2, s[20:23], s41 offen lds
    s_cmp_ge_u32 s32, 4
    s_cbranch_scc1 L_p1_rwo1
    s_add_u32 s41, s42, 98304
    s_mov_b32 m0, s41
    s_add_u32 s41, s41, s52
    buffer_load_dwordx4 v2, s[20:23], s41 offen lds
L_p1_rwo1:
    s_waitcnt vmcnt(0)
    s_barrier
    s_mov_b32 s49, 0
L_p1_rwl:
    s_lshl_b32 s41, s49, 3
    s_add_u32 s41, s41, s32
    s_cmp_ge_u32 s41, 100
    s_cbranch_scc1 L_p1_rdone
    s_mul_i32 s42, s41, 3277
    s_lshr_b32 s42, s42, 16
    s_mul_i32 s3, s42, 20
    s_sub_u32 s3, s41, s3
    s_mul_i32 s51, s40, 100
    s_add_u32 s51, s51, s41
    s_lshl_b32 s51, s51, 10
    s_add_u32 s51, s51, 16121856
    s_lshl_b32 s3, s3, 6
    s_lshl_b32 s42, s42, 1
    v_add_u32 v7, s42, v10
    v_mul_u32_u24 v8, 52429, v7
    v_lshrrev_b32 v8, 18, v8
    v_mul_u32_u24 v9, 5, v8
    v_sub_u32 v9, v7, v9
    v_mul_u32_u24 v8, 40, v8
    v_lshlrev_b32 v12, 3, v9
    v_cmp_lt_u32 vcc, 1, v9
    v_add_u32 v13, 4, v12
    s_nop 0
    v_cndmask_b32 v12, v12, v13, vcc
    v_cmp_eq_u32 vcc, 4, v9
    v_add_u32 v13, 4, v12
    v_mov_b32 v14, 36
    v_cndmask_b32 v12, v12, 16, vcc
    v_cndmask_b32 v13, v13, v14, vcc
    v_add3_u32 v12, v12, v8, v6
    v_add3_u32 v13, v13, v8, v6
    v_mul_u32_u24 v12, 1280, v12
    v_mul_u32_u24 v13, 1280, v13
    v_add3_u32 v12, v12, v11, s3
    v_add3_u32 v13, v13, v11, s3
    ds_read_b64_tr_b16 v[32:33], v12
    ds_read_b64_tr_b16 v[34:35], v13
    s_add_u32 s49, s49, 1
    s_waitcnt lgkmcnt(0)
    buffer_store_dwordx4 v[32:35], v2, s[28:31], s51 offen sc0 sc1
    s_nop 1
    s_branch L_p1_rwl
L_p1_sdone:
    s_mov_b32 s39, 0
    s_branch L_p1_spoll
L_p1_rdone:
    s_mov_b32 s39, 1
L_p1_spoll:
    s_waitcnt vmcnt(0)
    s_barrier
    s_cmp_lg_u32 s32, 0
    s_cbranch_scc1 L_p1_sbar
    v_mov_b32 v7, 0
    s_mov_b32 s42, 0
L_p1_ipoll:
    buffer_load_dword v8, v7, s[56:59], 0 offen sc1
    s_add_u32 s42, s42, 1
    s_waitcnt vmcnt(0)
    v_readfirstlane_b32 s41, v8
    s_cmp_ge_u32 s41, 5
    s_cbranch_scc1 L_p1_igot
    s_cmp_ge_u32 s42, 0x40000
    s_cbranch_scc1 L_p1_igot
    s_sleep 8
    s_branch L_p1_ipoll
L_p1_igot:
    s_cmp_eq_u32 s39, 0
    s_cbranch_scc1 L_p1_sbar
    v_lshlrev_b32 v7, 8, v1
    v_mov_b32 v8, 1
    s_mov_b32 s3, 22239232
    s_mov_b64 exec, 0xff
    buffer_atomic_add v8, v7, s[28:31], s3 offen sc1
    s_mov_b64 exec, -1
L_p1_sbar:
    s_barrier
    s_branch L_p2_entry
L_p1_end:
    s_waitcnt vmcnt(0)
    s_barrier
    s_cmp_lg_u32 s32, 0
    s_cbranch_scc1 L_p2_entry
    s_add_u32 s41, s34, 64
    s_add_u32 s42, s33, 80
    s_cmp_ge_u32 s34, 15
    s_cselect_b32 s41, s42, s41
    s_lshl_b32 s41, s41, 8
    s_add_u32 s41, s41, 22216704
    v_mov_b32 v7, 0
    v_mov_b32 v8, 1
    s_mov_b64 exec, 1
    buffer_atomic_add v8, v7, s[28:31], s41 offen sc1
    s_mov_b64 exec, -1
    s_branch L_p2_entry
L_p1_exit:
    s_endpgm
L_p2_entry:
    s_waitcnt vmcnt(0)
    s_load_dwordx2 s[4:5], s[0:1], 64
    s_load_dwordx2 s[6:7], s[0:1], 0
    s_load_dwordx4 s[12:15], s[0:1], 48
    v_lshrrev_b32 v2, 6, v0
    v_and_b32 v1, 63, v0
    v_readfirstlane_b32 s32, v2
    s_and_b32 s37, s2, 7
    s_lshr_b32 s38, s2, 3
    s_lshl_b32 s33, s37, 2
    s_and_b32 s3, s38, 3
    s_add_u32 s33, s33, s3
    s_mul_i32 s35, s33, 5
    s_add_u32 s35, s35, 1
    s_lshr_b32 s35, s35, 1
    s_and_b32 s45, s33, 1
    s_cmp_eq_u32 s45, 0
    s_cselect_b32 s3, 2, -1
    s_add_u32 s44, s35, s3
    s_lshl_b32 s35, s35, 9
    s_lshl_b32 s44, s44, 9
    s_lshl_b32 s45, s45, 3
    v_lshlrev_b32 v2, 4, v1
    v_and_b32 v3, 31, v1
    v_lshrrev_b32 v11, 5, v1
    s_cmp_ge_u32 s32, 4
    s_cbranch_scc1 L_p2_bg
    s_lshr_b32 s34, s38, 2
    s_lshl_b32 s34, s34, 3
    s_lshl_b32 s3, s32, 1
    s_add_u32 s34, s34, s3
    v_lshlrev_b32 v5, 4, v3
    v_lshl_add_u32 v4, v11, 9, v5
    v_add_u32 v5, s45, v5
    s_mul_i32 s3, s34, 40960
    s_add_u32 s37, s3, s35
    s_add_u32 s38, s3, s44
    v_mov_b32 v20, 0
    v_mov_b32 v21, 0
    v_mov_b32 v22, 0
    v_mov_b32 v23, 0
    s_waitcnt lgkmcnt(0)
    s_mov_b32 s8, s4
    s_mov_b32 s9, s5
    s_mov_b32 s10, 23068672
    s_mov_b32 s11, 0x00020000
    s_add_u32 s49, s37, 40960
    s_add_u32 s50, s38, 40960
    s_barrier
    buffer_load_dwordx4 v[12:15], v4, s[8:11], s37 offen sc1
    buffer_load_dwordx4 v[16:19], v4, s[8:11], s49 offen sc1
    s_mov_b64 exec, 0xffffffff
    buffer_load_dwordx2 v[20:21], v5, s[8:11], s38 offen sc1
    buffer_load_dwordx2 v[22:23], v5, s[8:11], s50 offen sc1
    s_mov_b64 exec, -1
    s_setprio 2
    s_mov_b32 s40, 0x000fffff
    s_mov_b32 s41, 0x000fffff
    v_mul_u32_u24 v6, 320, v11
    v_lshl_add_u32 v6, v3, 4, v6
    v_cmp_eq_u32 vcc, 20, v3
    v_mov_b32 v11, 55312
    v_mov_b32 v8, 55296
    v_cndmask_b32 v11, v11, v8, vcc
    v_cmp_gt_u32 vcc, 20, v3
    v_mov_b32 v7, 0
    s_nop 0
    v_cndmask_b32 v6, v11, v6, vcc
    v_cndmask_b32 v7, v7, 1, vcc
    v_mov_b32 v48, 0
    v_mov_b32 v56, 0
    v_mov_b32 v49, 0
    v_mov_b32 v57, 0
    v_mov_b32 v50, 0
    v_mov_b32 v58, 0
    v_mov_b32 v51, 0
    v_mov_b32 v59, 0
    v_mov_b32 v96, 0
    v_mov_b32 v97, 0
    v_mov_b32 v98, 0
    v_mov_b32 v99, 0
    v_mov_b32 v100, 0
    v_mov_b32 v101, 0
    v_mov_b32 v102, 0
    v_mov_b32 v103, 0
    v_mov_b32 v104, 0
    v_mov_b32 v105, 0
    v_mov_b32 v106, 0
    v_mov_b32 v107, 0
    v_mov_b32 v108, 0
    v_mov_b32 v109, 0
    v_mov_b32 v110, 0
    v_mov_b32 v111, 0
    v_mov_b32 v112, 0
    v_mov_b32 v113, 0
    v_mov_b32 v114, 0
    v_mov_b32 v115, 0
    v_mov_b32 v116, 0
    v_mov_b32 v117, 0
    v_mov_b32 v118, 0
    v_mov_b32 v119, 0
    v_mov_b32 v120, 0
    v_mov_b32 v121, 0
    v_mov_b32 v122, 0
    v_mov_b32 v123, 0
    v_mov_b32 v124, 0
    v_mov_b32 v125, 0
    v_mov_b32 v126, 0
    v_mov_b32 v127, 0
    s_mov_b32 s36, 0
    s_mov_b32 s39, 0
    s_waitcnt vmcnt(0)
    s_barrier
    ds_read_b128 v[24:27], v4 offset:0
    ds_read_b64 v[32:33], v5 offset:8192
    ds_read_b128 v[36:39], v6 offset:12288
    ds_read_b128 v[44:47], v6 offset:12928
    s_waitcnt lgkmcnt(2)
    v_mfma_f32_32x32x16_bf16 v[64:79], v[24:27], v[12:15], 0
    v_mfma_f32_32x32x16_bf16 v[80:95], v[24:27], v[16:19], 0
    v_mfma_f32_32x32x8bf16_1k v[64:79], v[32:33], v[20:21], v[64:79]
    v_mfma_f32_32x32x8bf16_1k v[80:95], v[32:33], v[22:23], v[80:95]
    s_nop 10
    v_max3_f32 v3, v64, v65, v66
    v_max3_f32 v3, v3, v67, v68
    v_max3_f32 v3, v3, v69, v70
    v_max3_f32 v3, v3, v71, v72
    v_max3_f32 v3, v3, v73, v74
    v_max3_f32 v3, v3, v75, v76
    v_max3_f32 v3, v3, v77, v78
    v_max_f32 v3, v3, v79
    v_max3_f32 v11, v80, v81, v82
    v_max3_f32 v11, v11, v83, v84
    v_max3_f32 v11, v11, v85, v86
    v_max3_f32 v11, v11, v87, v88
    v_max3_f32 v11, v11, v89, v90
    v_max3_f32 v11, v11, v91, v92
    v_max3_f32 v11, v11, v93, v94
    v_max_f32 v11, v11, v95
    v_mov_b32 v52, v3
    v_mov_b32 v53, v11
    s_nop 1
    v_permlane32_swap_b32 v3, v52
    v_permlane32_swap_b32 v11, v53
    v_max_f32 v3, v3, v52
    v_max_f32 v11, v11, v53
    v_sub_f32 v128, 0, v3
    v_sub_f32 v129, 0, v3
    v_sub_f32 v130, 0, v3
    v_sub_f32 v131, 0, v3
    v_sub_f32 v132, 0, v3
    v_sub_f32 v133, 0, v3
    v_sub_f32 v134, 0, v3
    v_sub_f32 v135, 0, v3
    v_sub_f32 v136, 0, v3
    v_sub_f32 v137, 0, v3
    v_sub_f32 v138, 0, v3
    v_sub_f32 v139, 0, v3
    v_sub_f32 v140, 0, v3
    v_sub_f32 v141, 0, v3
    v_sub_f32 v142, 0, v3
    v_sub_f32 v143, 0, v3
    v_sub_f32 v144, 0, v11
    v_sub_f32 v145, 0, v11
    v_sub_f32 v146, 0, v11
    v_sub_f32 v147, 0, v11
    v_sub_f32 v148, 0, v11
    v_sub_f32 v149, 0, v11
    v_sub_f32 v150, 0, v11
    v_sub_f32 v151, 0, v11
    v_sub_f32 v152, 0, v11
    v_sub_f32 v153, 0, v11
    v_sub_f32 v154, 0, v11
    v_sub_f32 v155, 0, v11
    v_sub_f32 v156, 0, v11
    v_sub_f32 v157, 0, v11
    v_sub_f32 v158, 0, v11
    v_sub_f32 v159, 0, v11
    s_waitcnt lgkmcnt(0)
    s_nop 0
    v_mfma_f32_32x32x16_bf16 v[64:79], v[24:27], v[12:15], v[128:143]
    v_mfma_f32_32x32x8bf16_1k v[64:79], v[32:33], v[20:21], v[64:79]
    s_nop 11
L_p2_loop:
    v_mfma_f32_32x32x16_bf16 v[80:95], v[24:27], v[16:19], v[144:159]
    v_exp_f32 v64, v64
    v_exp_f32 v65, v65
    v_exp_f32 v66, v66
    v_exp_f32 v67, v67
    v_cvt_pk_bf16_f32 v52, v64, v65
    v_cvt_pk_bf16_f32 v53, v66, v67
    v_mfma_f32_32x32x16_bf16 v[112:127], v[48:51], v[56:59], v[112:127]
    ds_read_b128 v[28:31], v4 offset:1024
    ds_read_b64 v[34:35], v5 offset:8704
    ds_read_b128 v[40:43], v6 offset:13568
    ds_read_b128 v[48:51], v6 offset:14208
    v_exp_f32 v68, v68
    v_exp_f32 v69, v69
    v_exp_f32 v70, v70
    v_exp_f32 v71, v71
    v_cvt_pk_bf16_f32 v54, v68, v69
    v_cvt_pk_bf16_f32 v55, v70, v71
    v_mfma_f32_32x32x8bf16_1k v[80:95], v[32:33], v[22:23], v[80:95]
    v_exp_f32 v72, v72
    v_exp_f32 v73, v73
    v_exp_f32 v74, v74
    v_exp_f32 v75, v75
    v_cvt_pk_bf16_f32 v56, v72, v73
    v_cvt_pk_bf16_f32 v57, v74, v75
    v_mfma_f32_32x32x16_bf16 v[96:111], v[36:39], v[52:55], v[96:111]
    s_waitcnt lgkmcnt(0)
    v_exp_f32 v76, v76
    v_exp_f32 v77, v77
    v_exp_f32 v78, v78
    v_exp_f32 v79, v79
    v_cvt_pk_bf16_f32 v58, v76, v77
    v_cvt_pk_bf16_f32 v59, v78, v79
    v_mfma_f32_32x32x16_bf16 v[64:79], v[28:31], v[12:15], v[128:143]
    v_exp_f32 v80, v80
    v_exp_f32 v81, v81
    v_exp_f32 v82, v82
    v_exp_f32 v83, v83
    v_cvt_pk_bf16_f32 v52, v80, v81
    v_cvt_pk_bf16_f32 v53, v82, v83
    v_mfma_f32_32x32x16_bf16 v[96:111], v[44:47], v[56:59], v[96:111]
    v_exp_f32 v84, v84
    v_exp_f32 v85, v85
    v_exp_f32 v86, v86
    v_exp_f32 v87, v87
    v_cvt_pk_bf16_f32 v54, v84, v85
    v_cvt_pk_bf16_f32 v55, v86, v87
    v_mfma_f32_32x32x8bf16_1k v[64:79], v[34:35], v[20:21], v[64:79]
    v_exp_f32 v88, v88
    v_exp_f32 v89, v89
    v_exp_f32 v90, v90
    v_exp_f32 v91, v91
    v_cvt_pk_bf16_f32 v56, v88, v89
    v_cvt_pk_bf16_f32 v57, v90, v91
    v_mfma_f32_32x32x16_bf16 v[112:127], v[36:39], v[52:55], v[112:127]
    v_exp_f32 v92, v92
    v_exp_f32 v93, v93
    v_exp_f32 v94, v94
    v_exp_f32 v95, v95
    v_cvt_pk_bf16_f32 v58, v92, v93
    v_cvt_pk_bf16_f32 v59, v94, v95
    v_mfma_f32_32x32x16_bf16 v[80:95], v[28:31], v[16:19], v[144:159]
    v_exp_f32 v64, v64
    v_exp_f32 v65, v65
    v_exp_f32 v66, v66
    v_exp_f32 v67, v67
    v_cvt_pk_bf16_f32 v52, v64, v65
    v_cvt_pk_bf16_f32 v53, v66, v67
    v_mfma_f32_32x32x16_bf16 v[112:127], v[44:47], v[56:59], v[112:127]
    ds_read_b128 v[24:27], v4 offset:2048
    ds_read_b64 v[32:33], v5 offset:9216
    ds_read_b128 v[36:39], v6 offset:14848
    ds_read_b128 v[44:47], v6 offset:15488
    v_exp_f32 v68, v68
    v_exp_f32 v69, v69
    v_exp_f32 v70, v70
    v_exp_f32 v71, v71
    v_cvt_pk_bf16_f32 v54, v68, v69
    v_cvt_pk_bf16_f32 v55, v70, v71
    v_mfma_f32_32x32x8bf16_1k v[80:95], v[34:35], v[22:23], v[80:95]
    v_exp_f32 v72, v72
    v_exp_f32 v73, v73
    v_exp_f32 v74, v74
    v_exp_f32 v75, v75
    v_cvt_pk_bf16_f32 v56, v72, v73
    v_cvt_pk_bf16_f32 v57, v74, v75
    v_mfma_f32_32x32x16_bf16 v[96:111], v[40:43], v[52:55], v[96:111]
    s_waitcnt lgkmcnt(0)
    v_exp_f32 v76, v76
    v_exp_f32 v77, v77
    v_exp_f32 v78, v78
    v_exp_f32 v79, v79
    v_cvt_pk_bf16_f32 v58, v76, v77
    v_cvt_pk_bf16_f32 v59, v78, v79
    v_mfma_f32_32x32x16_bf16 v[64:79], v[24:27], v[12:15], v[128:143]
    v_exp_f32 v80, v80
    v_exp_f32 v81, v81
    v_exp_f32 v82, v82
    v_exp_f32 v83, v83
    v_cvt_pk_bf16_f32 v52, v80, v81
    v_cvt_pk_bf16_f32 v53, v82, v83
    v_mfma_f32_32x32x16_bf16 v[96:111], v[48:51], v[56:59], v[96:111]
    v_exp_f32 v84, v84
    v_exp_f32 v85, v85
    v_exp_f32 v86, v86
    v_exp_f32 v87, v87
    v_cvt_pk_bf16_f32 v54, v84, v85
    v_cvt_pk_bf16_f32 v55, v86, v87
    v_mfma_f32_32x32x8bf16_1k v[64:79], v[32:33], v[20:21], v[64:79]
    v_exp_f32 v88, v88
    v_exp_f32 v89, v89
    v_exp_f32 v90, v90
    v_exp_f32 v91, v91
    v_cvt_pk_bf16_f32 v56, v88, v89
    v_cvt_pk_bf16_f32 v57, v90, v91
    v_mfma_f32_32x32x16_bf16 v[112:127], v[40:43], v[52:55], v[112:127]
    v_exp_f32 v92, v92
    v_exp_f32 v93, v93
    v_exp_f32 v94, v94
    v_exp_f32 v95, v95
    v_cvt_pk_bf16_f32 v58, v92, v93
    v_cvt_pk_bf16_f32 v59, v94, v95
    v_mfma_f32_32x32x16_bf16 v[80:95], v[24:27], v[16:19], v[144:159]
    v_exp_f32 v64, v64
    v_exp_f32 v65, v65
    v_exp_f32 v66, v66
    v_exp_f32 v67, v67
    v_cvt_pk_bf16_f32 v52, v64, v65
    v_cvt_pk_bf16_f32 v53, v66, v67
    v_mfma_f32_32x32x16_bf16 v[112:127], v[48:51], v[56:59], v[112:127]
    ds_read_b128 v[28:31], v4 offset:3072
    ds_read_b64 v[34:35], v5 offset:9728
    ds_read_b128 v[40:43], v6 offset:16128
    ds_read_b128 v[48:51], v6 offset:16768
    v_exp_f32 v68, v68
    v_exp_f32 v69, v69
    v_exp_f32 v70, v70
    v_exp_f32 v71, v71
    v_cvt_pk_bf16_f32 v54, v68, v69
    v_cvt_pk_bf16_f32 v55, v70, v71
    v_mfma_f32_32x32x8bf16_1k v[80:95], v[32:33], v[22:23], v[80:95]
    v_exp_f32 v72, v72
    v_exp_f32 v73, v73
    v_exp_f32 v74, v74
    v_exp_f32 v75, v75
    v_cvt_pk_bf16_f32 v56, v72, v73
    v_cvt_pk_bf16_f32 v57, v74, v75
    v_mfma_f32_32x32x16_bf16 v[96:111], v[36:39], v[52:55], v[96:111]
    s_waitcnt lgkmcnt(0)
    v_exp_f32 v76, v76
    v_exp_f32 v77, v77
    v_exp_f32 v78, v78
    v_exp_f32 v79, v79
    v_cvt_pk_bf16_f32 v58, v76, v77
    v_cvt_pk_bf16_f32 v59, v78, v79
    v_mfma_f32_32x32x16_bf16 v[64:79], v[28:31], v[12:15], v[128:143]
    v_exp_f32 v80, v80
    v_exp_f32 v81, v81
    v_exp_f32 v82, v82
    v_exp_f32 v83, v83
    v_cvt_pk_bf16_f32 v52, v80, v81
    v_cvt_pk_bf16_f32 v53, v82, v83
    v_mfma_f32_32x32x16_bf16 v[96:111], v[44:47], v[56:59], v[96:111]
    v_exp_f32 v84, v84
    v_exp_f32 v85, v85
    v_exp_f32 v86, v86
    v_exp_f32 v87, v87
    v_cvt_pk_bf16_f32 v54, v84, v85
    v_cvt_pk_bf16_f32 v55, v86, v87
    v_mfma_f32_32x32x8bf16_1k v[64:79], v[34:35], v[20:21], v[64:79]
    v_exp_f32 v88, v88
    v_exp_f32 v89, v89
    v_exp_f32 v90, v90
    v_exp_f32 v91, v91
    v_cvt_pk_bf16_f32 v56, v88, v89
    v_cvt_pk_bf16_f32 v57, v90, v91
    v_mfma_f32_32x32x16_bf16 v[112:127], v[36:39], v[52:55], v[112:127]
    v_exp_f32 v92, v92
    v_exp_f32 v93, v93
    v_exp_f32 v94, v94
    v_exp_f32 v95, v95
    v_cvt_pk_bf16_f32 v58, v92, v93
    v_cvt_pk_bf16_f32 v59, v94, v95
    v_mfma_f32_32x32x16_bf16 v[80:95], v[28:31], v[16:19], v[144:159]
    v_exp_f32 v64, v64
    v_exp_f32 v65, v65
    v_exp_f32 v66, v66
    v_exp_f32 v67, v67
    v_cvt_pk_bf16_f32 v52, v64, v65
    v_cvt_pk_bf16_f32 v53, v66, v67
    v_mfma_f32_32x32x16_bf16 v[112:127], v[44:47], v[56:59], v[112:127]
    ds_read_b128 v[24:27], v4 offset:4096
    ds_read_b64 v[32:33], v5 offset:10240
    ds_read_b128 v[36:39], v6 offset:17408
    ds_read_b128 v[44:47], v6 offset:18048
    v_exp_f32 v68, v68
    v_exp_f32 v69, v69
    v_exp_f32 v70, v70
    v_exp_f32 v71, v71
    v_cvt_pk_bf16_f32 v54, v68, v69
    v_cvt_pk_bf16_f32 v55, v70, v71
    v_mfma_f32_32x32x8bf16_1k v[80:95], v[34:35], v[22:23], v[80:95]
    v_exp_f32 v72, v72
    v_exp_f32 v73, v73
    v_exp_f32 v74, v74
    v_exp_f32 v75, v75
    v_cvt_pk_bf16_f32 v56, v72, v73
    v_cvt_pk_bf16_f32 v57, v74, v75
    v_mfma_f32_32x32x16_bf16 v[96:111], v[40:43], v[52:55], v[96:111]
    s_waitcnt lgkmcnt(0)
    v_exp_f32 v76, v76
    v_exp_f32 v77, v77
    v_exp_f32 v78, v78
    v_exp_f32 v79, v79
    v_cvt_pk_bf16_f32 v58, v76, v77
    v_cvt_pk_bf16_f32 v59, v78, v79
    v_mfma_f32_32x32x16_bf16 v[64:79], v[24:27], v[12:15], v[128:143]
    v_exp_f32 v80, v80
    v_exp_f32 v81, v81
    v_exp_f32 v82, v82
    v_exp_f32 v83, v83
    v_cvt_pk_bf16_f32 v52, v80, v81
    v_cvt_pk_bf16_f32 v53, v82, v83
    v_mfma_f32_32x32x16_bf16 v[96:111], v[48:51], v[56:59], v[96:111]
    v_exp_f32 v84, v84
    v_exp_f32 v85, v85
    v_exp_f32 v86, v86
    v_exp_f32 v87, v87
    v_cvt_pk_bf16_f32 v54, v84, v85
    v_cvt_pk_bf16_f32 v55, v86, v87
    v_mfma_f32_32x32x8bf16_1k v[64:79], v[32:33], v[20:21], v[64:79]
    v_exp_f32 v88, v88
    v_exp_f32 v89, v89
    v_exp_f32 v90, v90
    v_exp_f32 v91, v91
    v_cvt_pk_bf16_f32 v56, v88, v89
    v_cvt_pk_bf16_f32 v57, v90, v91
    v_mfma_f32_32x32x16_bf16 v[112:127], v[40:43], v[52:55], v[112:127]
    v_exp_f32 v92, v92
    v_exp_f32 v93, v93
    v_exp_f32 v94, v94
    v_exp_f32 v95, v95
    v_cvt_pk_bf16_f32 v58, v92, v93
    v_cvt_pk_bf16_f32 v59, v94, v95
    v_mfma_f32_32x32x16_bf16 v[80:95], v[24:27], v[16:19], v[144:159]
    v_exp_f32 v64, v64
    v_exp_f32 v65, v65
    v_exp_f32 v66, v66
    v_exp_f32 v67, v67
    v_cvt_pk_bf16_f32 v52, v64, v65
    v_cvt_pk_bf16_f32 v53, v66, v67
    v_mfma_f32_32x32x16_bf16 v[112:127], v[48:51], v[56:59], v[112:127]
    ds_read_b128 v[28:31], v4 offset:5120
    ds_read_b64 v[34:35], v5 offset:10752
    ds_read_b128 v[40:43], v6 offset:18688
    ds_read_b128 v[48:51], v6 offset:19328
    v_exp_f32 v68, v68
    v_exp_f32 v69, v69
    v_exp_f32 v70, v70
    v_exp_f32 v71, v71
    v_cvt_pk_bf16_f32 v54, v68, v69
    v_cvt_pk_bf16_f32 v55, v70, v71
    v_mfma_f32_32x32x8bf16_1k v[80:95], v[32:33], v[22:23], v[80:95]
    v_exp_f32 v72, v72
    v_exp_f32 v73, v73
    v_exp_f32 v74, v74
    v_exp_f32 v75, v75
    v_cvt_pk_bf16_f32 v56, v72, v73
    v_cvt_pk_bf16_f32 v57, v74, v75
    v_mfma_f32_32x32x16_bf16 v[96:111], v[36:39], v[52:55], v[96:111]
    s_waitcnt lgkmcnt(0)
    v_exp_f32 v76, v76
    v_exp_f32 v77, v77
    v_exp_f32 v78, v78
    v_exp_f32 v79, v79
    v_cvt_pk_bf16_f32 v58, v76, v77
    v_cvt_pk_bf16_f32 v59, v78, v79
    v_mfma_f32_32x32x16_bf16 v[64:79], v[28:31], v[12:15], v[128:143]
    v_exp_f32 v80, v80
    v_exp_f32 v81, v81
    v_exp_f32 v82, v82
    v_exp_f32 v83, v83
    v_cvt_pk_bf16_f32 v52, v80, v81
    v_cvt_pk_bf16_f32 v53, v82, v83
    v_mfma_f32_32x32x16_bf16 v[96:111], v[44:47], v[56:59], v[96:111]
    v_exp_f32 v84, v84
    v_exp_f32 v85, v85
    v_exp_f32 v86, v86
    v_exp_f32 v87, v87
    v_cvt_pk_bf16_f32 v54, v84, v85
    v_cvt_pk_bf16_f32 v55, v86, v87
    v_mfma_f32_32x32x8bf16_1k v[64:79], v[34:35], v[20:21], v[64:79]
    v_exp_f32 v88, v88
    v_exp_f32 v89, v89
    v_exp_f32 v90, v90
    v_exp_f32 v91, v91
    v_cvt_pk_bf16_f32 v56, v88, v89
    v_cvt_pk_bf16_f32 v57, v90, v91
    v_mfma_f32_32x32x16_bf16 v[112:127], v[36:39], v[52:55], v[112:127]
    v_exp_f32 v92, v92
    v_exp_f32 v93, v93
    v_exp_f32 v94, v94
    v_exp_f32 v95, v95
    v_cvt_pk_bf16_f32 v58, v92, v93
    v_cvt_pk_bf16_f32 v59, v94, v95
    v_mfma_f32_32x32x16_bf16 v[80:95], v[28:31], v[16:19], v[144:159]
    v_exp_f32 v64, v64
    v_exp_f32 v65, v65
    v_exp_f32 v66, v66
    v_exp_f32 v67, v67
    v_cvt_pk_bf16_f32 v52, v64, v65
    v_cvt_pk_bf16_f32 v53, v66, v67
    v_mfma_f32_32x32x16_bf16 v[112:127], v[44:47], v[56:59], v[112:127]
    ds_read_b128 v[24:27], v4 offset:6144
    ds_read_b64 v[32:33], v5 offset:11264
    ds_read_b128 v[36:39], v6 offset:19968
    ds_read_b128 v[44:47], v6 offset:20608
    v_exp_f32 v68, v68
    v_exp_f32 v69, v69
    v_exp_f32 v70, v70
    v_exp_f32 v71, v71
    v_cvt_pk_bf16_f32 v54, v68, v69
    v_cvt_pk_bf16_f32 v55, v70, v71
    v_mfma_f32_32x32x8bf16_1k v[80:95], v[34:35], v[22:23], v[80:95]
    v_exp_f32 v72, v72
    v_exp_f32 v73, v73
    v_exp_f32 v74, v74
    v_exp_f32 v75, v75
    v_cvt_pk_bf16_f32 v56, v72, v73
    v_cvt_pk_bf16_f32 v57, v74, v75
    v_mfma_f32_32x32x16_bf16 v[96:111], v[40:43], v[52:55], v[96:111]
    s_waitcnt lgkmcnt(0)
    v_exp_f32 v76, v76
    v_exp_f32 v77, v77
    v_exp_f32 v78, v78
    v_exp_f32 v79, v79
    v_cvt_pk_bf16_f32 v58, v76, v77
    v_cvt_pk_bf16_f32 v59, v78, v79
    v_mfma_f32_32x32x16_bf16 v[64:79], v[24:27], v[12:15], v[128:143]
    v_exp_f32 v80, v80
    v_exp_f32 v81, v81
    v_exp_f32 v82, v82
    v_exp_f32 v83, v83
    v_cvt_pk_bf16_f32 v52, v80, v81
    v_cvt_pk_bf16_f32 v53, v82, v83
    v_mfma_f32_32x32x16_bf16 v[96:111], v[48:51], v[56:59], v[96:111]
    v_exp_f32 v84, v84
    v_exp_f32 v85, v85
    v_exp_f32 v86, v86
    v_exp_f32 v87, v87
    v_cvt_pk_bf16_f32 v54, v84, v85
    v_cvt_pk_bf16_f32 v55, v86, v87
    v_mfma_f32_32x32x8bf16_1k v[64:79], v[32:33], v[20:21], v[64:79]
    v_exp_f32 v88, v88
    v_exp_f32 v89, v89
    v_exp_f32 v90, v90
    v_exp_f32 v91, v91
    v_cvt_pk_bf16_f32 v56, v88, v89
    v_cvt_pk_bf16_f32 v57, v90, v91
    v_mfma_f32_32x32x16_bf16 v[112:127], v[40:43], v[52:55], v[112:127]
    v_exp_f32 v92, v92
    v_exp_f32 v93, v93
    v_exp_f32 v94, v94
    v_exp_f32 v95, v95
    v_cvt_pk_bf16_f32 v58, v92, v93
    v_cvt_pk_bf16_f32 v59, v94, v95
    v_mfma_f32_32x32x16_bf16 v[80:95], v[24:27], v[16:19], v[144:159]
    v_exp_f32 v64, v64
    v_exp_f32 v65, v65
    v_exp_f32 v66, v66
    v_exp_f32 v67, v67
    v_cvt_pk_bf16_f32 v52, v64, v65
    v_cvt_pk_bf16_f32 v53, v66, v67
    v_mfma_f32_32x32x16_bf16 v[112:127], v[48:51], v[56:59], v[112:127]
    ds_read_b128 v[28:31], v4 offset:7168
    ds_read_b64 v[34:35], v5 offset:11776
    ds_read_b128 v[40:43], v6 offset:21248
    ds_read_b128 v[48:51], v6 offset:21888
    v_exp_f32 v68, v68
    v_exp_f32 v69, v69
    v_exp_f32 v70, v70
    v_exp_f32 v71, v71
    v_cvt_pk_bf16_f32 v54, v68, v69
    v_cvt_pk_bf16_f32 v55, v70, v71
    v_mfma_f32_32x32x8bf16_1k v[80:95], v[32:33], v[22:23], v[80:95]
    v_exp_f32 v72, v72
    v_exp_f32 v73, v73
    v_exp_f32 v74, v74
    v_exp_f32 v75, v75
    v_cvt_pk_bf16_f32 v56, v72, v73
    v_cvt_pk_bf16_f32 v57, v74, v75
    v_mfma_f32_32x32x16_bf16 v[96:111], v[36:39], v[52:55], v[96:111]
    s_waitcnt lgkmcnt(0)
    v_exp_f32 v76, v76
    v_exp_f32 v77, v77
    v_exp_f32 v78, v78
    v_exp_f32 v79, v79
    v_cvt_pk_bf16_f32 v58, v76, v77
    v_cvt_pk_bf16_f32 v59, v78, v79
    v_mfma_f32_32x32x16_bf16 v[64:79], v[28:31], v[12:15], v[128:143]
    v_exp_f32 v80, v80
    v_exp_f32 v81, v81
    v_exp_f32 v82, v82
    v_exp_f32 v83, v83
    v_cvt_pk_bf16_f32 v52, v80, v81
    v_cvt_pk_bf16_f32 v53, v82, v83
    v_mfma_f32_32x32x16_bf16 v[96:111], v[44:47], v[56:59], v[96:111]
    v_exp_f32 v84, v84
    v_exp_f32 v85, v85
    v_exp_f32 v86, v86
    v_exp_f32 v87, v87
    v_cvt_pk_bf16_f32 v54, v84, v85
    v_cvt_pk_bf16_f32 v55, v86, v87
    v_mfma_f32_32x32x8bf16_1k v[64:79], v[34:35], v[20:21], v[64:79]
    v_exp_f32 v88, v88
    v_exp_f32 v89, v89
    v_exp_f32 v90, v90
    v_exp_f32 v91, v91
    v_cvt_pk_bf16_f32 v56, v88, v89
    v_cvt_pk_bf16_f32 v57, v90, v91
    v_mfma_f32_32x32x16_bf16 v[112:127], v[36:39], v[52:55], v[112:127]
    v_exp_f32 v92, v92
    v_exp_f32 v93, v93
    v_exp_f32 v94, v94
    v_exp_f32 v95, v95
    v_cvt_pk_bf16_f32 v58, v92, v93
    v_cvt_pk_bf16_f32 v59, v94, v95
    v_mfma_f32_32x32x16_bf16 v[80:95], v[28:31], v[16:19], v[144:159]
    v_exp_f32 v64, v64
    v_exp_f32 v65, v65
    v_exp_f32 v66, v66
    v_exp_f32 v67, v67
    v_cvt_pk_bf16_f32 v52, v64, v65
    v_cvt_pk_bf16_f32 v53, v66, v67
    v_mfma_f32_32x32x16_bf16 v[112:127], v[44:47], v[56:59], v[112:127]
    s_barrier
    s_cmp_eq_u32 s39, 2
    s_mov_b32 s37, 22528
    s_cselect_b32 s37, 4294922240, s37
    s_cselect_b32 s39, -1, s39
    s_add_u32 s39, s39, 1
    v_add_u32 v4, s37, v4
    v_add_u32 v5, s37, v5
    v_mad_i32_i24 v6, v7, s37, v6
    ds_read_b128 v[24:27], v4 offset:0
    ds_read_b64 v[32:33], v5 offset:8192
    ds_read_b128 v[36:39], v6 offset:12288
    ds_read_b128 v[44:47], v6 offset:12928
    v_exp_f32 v68, v68
    v_exp_f32 v69, v69
    v_exp_f32 v70, v70
    v_exp_f32 v71, v71
    v_cvt_pk_bf16_f32 v54, v68, v69
    v_cvt_pk_bf16_f32 v55, v70, v71
    v_mfma_f32_32x32x8bf16_1k v[80:95], v[34:35], v[22:23], v[80:95]
    v_exp_f32 v72, v72
    v_exp_f32 v73, v73
    v_exp_f32 v74, v74
    v_exp_f32 v75, v75
    v_cvt_pk_bf16_f32 v56, v72, v73
    v_cvt_pk_bf16_f32 v57, v74, v75
    v_mfma_f32_32x32x16_bf16 v[96:111], v[40:43], v[52:55], v[96:111]
    s_waitcnt lgkmcnt(0)
    v_exp_f32 v76, v76
    v_exp_f32 v77, v77
    v_exp_f32 v78, v78
    v_exp_f32 v79, v79
    v_cvt_pk_bf16_f32 v58, v76, v77
    v_cvt_pk_bf16_f32 v59, v78, v79
    v_mfma_f32_32x32x16_bf16 v[64:79], v[24:27], v[12:15], v[128:143]
    v_exp_f32 v80, v80
    v_exp_f32 v81, v81
    v_exp_f32 v82, v82
    v_exp_f32 v83, v83
    v_cvt_pk_bf16_f32 v52, v80, v81
    v_cvt_pk_bf16_f32 v53, v82, v83
    v_mfma_f32_32x32x16_bf16 v[96:111], v[48:51], v[56:59], v[96:111]
    v_exp_f32 v84, v84
    v_exp_f32 v85, v85
    v_exp_f32 v86, v86
    v_exp_f32 v87, v87
    v_cvt_pk_bf16_f32 v54, v84, v85
    v_cvt_pk_bf16_f32 v55, v86, v87
    v_mfma_f32_32x32x8bf16_1k v[64:79], v[32:33], v[20:21], v[64:79]
    v_exp_f32 v88, v88
    v_exp_f32 v89, v89
    v_exp_f32 v90, v90
    v_exp_f32 v91, v91
    v_cvt_pk_bf16_f32 v56, v88, v89
    v_cvt_pk_bf16_f32 v57, v90, v91
    v_mfma_f32_32x32x16_bf16 v[112:127], v[40:43], v[52:55], v[112:127]
    v_exp_f32 v92, v92
    v_exp_f32 v93, v93
    v_exp_f32 v94, v94
    v_exp_f32 v95, v95
    v_cvt_pk_bf16_f32 v58, v92, v93
    v_cvt_pk_bf16_f32 v59, v94, v95
    s_add_u32 s36, s36, 1
    s_cmp_lt_u32 s36, 8
    s_cbranch_scc1 L_p2_loop
    s_nop 0
    v_mfma_f32_32x32x16_bf16 v[112:127], v[48:51], v[56:59], v[112:127]
    s_mov_b32 s54, 0
    s_lshr_b32 s49, s33, 1
    s_mul_i32 s49, s49, 5
    s_mul_i32 s3, s34, 80
    s_add_u32 s49, s49, s3
    s_lshl_b32 s49, s49, 9
    s_add_u32 s49, s49, 16941056
    s_add_u32 s50, s49, s45
    s_lshl_b32 s3, s45, 7
    s_add_u32 s49, s49, s3
    v_and_b32 v9, 31, v1
    v_lshrrev_b32 v8, 5, v1
    v_lshlrev_b32 v9, 4, v9
    v_lshl_add_u32 v8, v8, 9, v9
    s_waitcnt lgkmcnt(0)
L_p2_norm:
    v_mov_b32 v3, v104
    v_mov_b32 v11, v104
    s_mov_b32 s37, 0x2b800000
    s_mov_b32 s38, 0x5d800000
    v_permlane32_swap_b32 v3, v11
    v_pk_add_f32 v[60:61], v[96:97], v[98:99]
    v_rcp_f32 v10, v11
    v_pk_add_f32 v[62:63], v[100:101], v[102:103]
    v_med3_f32 v3, v11, s37, v11
    v_pk_add_f32 v[60:61], v[60:61], v[104:105]
    v_pk_add_f32 v[62:63], v[62:63], v[106:107]
    v_min_f32 v3, s38, v11
    v_max_f32 v3, s37, v3
    v_pk_add_f32 v[60:61], v[60:61], v[62:63]
    v_cmp_eq_f32 s[42:43], v3, v11
    v_add_f32 v60, v60, v61
    s_movk_i32 s3, 0x1f8
    v_cmp_class_f32 vcc, v60, s3
    s_and_b64 s[42:43], s[42:43], vcc
    s_cmp_eq_u64 s[42:43], -1
    s_cbranch_scc0 L_p2_slow
L_p2_fin:
    v_pk_mul_f32 v[96:97], v[96:97], v[10:11] op_sel_hi:[1,0]
    v_pk_mul_f32 v[98:99], v[98:99], v[10:11] op_sel_hi:[1,0]
    v_pk_mul_f32 v[100:101], v[100:101], v[10:11] op_sel_hi:[1,0]
    v_pk_mul_f32 v[102:103], v[102:103], v[10:11] op_sel_hi:[1,0]
    v_pk_mul_f32 v[104:105], v[104:105], v[10:11] op_sel_hi:[1,0]
    v_pk_mul_f32 v[106:107], v[106:107], v[10:11] op_sel_hi:[1,0]
    v_cvt_pk_bf16_f32 v96, v96, v97
    v_cvt_pk_bf16_f32 v97, v98, v99
    v_cvt_pk_bf16_f32 v98, v100, v101
    v_cvt_pk_bf16_f32 v99, v102, v103
    v_cvt_pk_bf16_f32 v100, v104, v105
    v_cvt_pk_bf16_f32 v101, v106, v107
    s_nop 0
    v_permlane32_swap_b32 v96, v98
    v_permlane32_swap_b32 v97, v99
    buffer_store_dwordx4 v[96:99], v8, s[8:11], s49 offen sc0 sc1
    s_mov_b64 exec, 0xffffffff
    buffer_store_dwordx2 v[100:101], v9, s[8:11], s50 offen offset:2048 sc0 sc1
    s_mov_b64 exec, -1
    s_cmp_lg_u32 s54, 0
    s_cbranch_scc1 L_p2_aend
    s_mov_b32 s54, 1
    s_add_u32 s49, s49, 40960
    s_add_u32 s50, s50, 40960
    v_mov_b32 v96, v112
    v_mov_b32 v97, v113
    v_mov_b32 v98, v114
    v_mov_b32 v99, v115
    v_mov_b32 v100, v116
    v_mov_b32 v101, v117
    v_mov_b32 v102, v118
    v_mov_b32 v103, v119
    v_mov_b32 v104, v120
    v_mov_b32 v105, v121
    v_mov_b32 v106, v122
    v_mov_b32 v107, v123
    v_mov_b32 v12, v16
    v_mov_b32 v13, v17
    v_mov_b32 v14, v18
    v_mov_b32 v15, v19
    v_mov_b32 v20, v22
    v_mov_b32 v21, v23
    s_branch L_p2_norm
L_p2_aend:
    s_lshl_b32 s37, s34, 8
    s_add_u32 s37, s37, 22216704
    s_add_u32 s38, s37, 256
    v_mov_b32 v8, 0
    v_mov_b32 v9, 1
    s_waitcnt vmcnt(2)
    s_mov_b64 exec, 1
    buffer_atomic_add v9, v8, s[8:11], s37 offen sc1
    s_waitcnt vmcnt(1)
    buffer_atomic_add v9, v8, s[8:11], s38 offen sc1
    s_mov_b64 exec, -1
    s_endpgm
L_p2_slow:
    v_and_b32 v10, 31, v1
    v_lshrrev_b32 v11, 5, v1
    v_lshlrev_b32 v5, 4, v10
    v_lshl_add_u32 v4, v11, 9, v5
    v_add_u32 v5, s45, v5
    v_mul_u32_u24 v6, 320, v11
    v_lshl_add_u32 v6, v10, 4, v6
    v_mov_b32 v128, 0xff800000
    v_mov_b32 v3, 0x3f803f80
    v_mov_b32 v36, v3
    v_mov_b32 v44, v3
    v_mov_b32 v37, v3
    v_mov_b32 v45, v3
    v_mov_b32 v38, v3
    v_mov_b32 v46, v3
    v_mov_b32 v39, v3
    v_mov_b32 v47, v3
    v_mov_b32 v96, 0
    v_mov_b32 v97, 0
    v_mov_b32 v98, 0
    v_mov_b32 v99, 0
    v_mov_b32 v100, 0
    v_mov_b32 v101, 0
    v_mov_b32 v102, 0
    v_mov_b32 v103, 0
    v_mov_b32 v104, 0
    v_mov_b32 v105, 0
    v_mov_b32 v106, 0
    v_mov_b32 v107, 0
    v_mov_b32 v108, 0
    v_mov_b32 v109, 0
    v_mov_b32 v110, 0
    v_mov_b32 v111, 0
    s_mov_b32 s36, 0
    s_add_u32 s46, s35, 2621440
    s_add_u32 s47, s44, 2621440
    s_mul_i32 s48, s33, 81920
    s_add_u32 s48, s48, 5242880
L_p2_sl:
    buffer_load_dwordx4 v[24:27], v4, s[8:11], s46 offen sc1
    buffer_load_dwordx2 v[32:33], v5, s[8:11], s47 offen sc1
    s_mov_b64 exec, s[40:41]
    buffer_load_dwordx4 v[36:39], v6, s[8:11], s48 offen sc1
    buffer_load_dwordx4 v[44:47], v6, s[8:11], s48 offen offset:640 sc1
    s_mov_b64 exec, -1
    s_waitcnt vmcnt(2)
    v_mfma_f32_32x32x16_bf16 v[64:79], v[24:27], v[12:15], 0
    v_mfma_f32_32x32x8bf16_1k v[64:79], v[32:33], v[20:21], v[64:79]
    s_nop 11
    v_max3_f32 v130, v64, v65, v66
    v_max3_f32 v130, v130, v67, v68
    v_max3_f32 v130, v130, v69, v70
    v_max3_f32 v130, v130, v71, v72
    v_max3_f32 v130, v130, v73, v74
    v_max3_f32 v130, v130, v75, v76
    v_max3_f32 v130, v130, v77, v78
    v_max3_f32 v130, v130, v79, v128
    v_mov_b32 v3, v130
    s_nop 1
    v_permlane32_swap_b32 v130, v3
    v_max_f32 v130, v130, v3
    v_sub_f32 v129, v128, v130
    v_exp_f32 v129, v129
    v_mov_b32 v128, v130
    v_sub_f32 v64, v64, v128
    v_sub_f32 v65, v65, v128
    v_sub_f32 v66, v66, v128
    v_sub_f32 v67, v67, v128
    v_sub_f32 v68, v68, v128
    v_sub_f32 v69, v69, v128
    v_sub_f32 v70, v70, v128
    v_sub_f32 v71, v71, v128
    v_sub_f32 v72, v72, v128
    v_sub_f32 v73, v73, v128
    v_sub_f32 v74, v74, v128
    v_sub_f32 v75, v75, v128
    v_sub_f32 v76, v76, v128
    v_sub_f32 v77, v77, v128
    v_sub_f32 v78, v78, v128
    v_sub_f32 v79, v79, v128
    v_exp_f32 v64, v64
    v_exp_f32 v65, v65
    v_exp_f32 v66, v66
    v_exp_f32 v67, v67
    v_exp_f32 v68, v68
    v_exp_f32 v69, v69
    v_exp_f32 v70, v70
    v_exp_f32 v71, v71
    v_exp_f32 v72, v72
    v_exp_f32 v73, v73
    v_exp_f32 v74, v74
    v_exp_f32 v75, v75
    v_exp_f32 v76, v76
    v_exp_f32 v77, v77
    v_exp_f32 v78, v78
    v_exp_f32 v79, v79
    v_mul_f32 v96, v96, v129
    v_mul_f32 v97, v97, v129
    v_mul_f32 v98, v98, v129
    v_mul_f32 v99, v99, v129
    v_mul_f32 v100, v100, v129
    v_mul_f32 v101, v101, v129
    v_mul_f32 v102, v102, v129
    v_mul_f32 v103, v103, v129
    v_mul_f32 v104, v104, v129
    v_mul_f32 v105, v105, v129
    v_mul_f32 v106, v106, v129
    v_mul_f32 v107, v107, v129
    v_mul_f32 v108, v108, v129
    v_mul_f32 v109, v109, v129
    v_mul_f32 v110, v110, v129
    v_mul_f32 v111, v111, v129
    v_cvt_pk_bf16_f32 v52, v64, v65
    v_cvt_pk_bf16_f32 v53, v66, v67
    v_cvt_pk_bf16_f32 v54, v68, v69
    v_cvt_pk_bf16_f32 v55, v70, v71
    v_cvt_pk_bf16_f32 v56, v72, v73
    v_cvt_pk_bf16_f32 v57, v74, v75
    v_cvt_pk_bf16_f32 v58, v76, v77
    v_cvt_pk_bf16_f32 v59, v78, v79
    s_waitcnt vmcnt(0)
    s_nop 0
    v_mfma_f32_32x32x16_bf16 v[96:111], v[36:39], v[52:55], v[96:111]
    v_mfma_f32_32x32x16_bf16 v[96:111], v[44:47], v[56:59], v[96:111]
    s_add_u32 s46, s46, 40960
    s_add_u32 s47, s47, 40960
    s_add_u32 s48, s48, 1280
    s_add_u32 s36, s36, 1
    s_cmp_lt_u32 s36, 64
    s_nop 6
    s_cbranch_scc1 L_p2_sl
    s_nop 3
    v_mov_b32 v3, v104
    v_mov_b32 v11, v104
    s_nop 1
    v_permlane32_swap_b32 v3, v11
    v_rcp_f32 v10, v11
    s_nop 0
    s_branch L_p2_fin
L_p2_bg:
    s_setprio 0
    s_sub_u32 s51, s32, 4
    v_mul_u32_u24 v3, 40960, v11
    v_and_b32 v4, 31, v1
    v_lshl_add_u32 v3, v4, 4, v3
    v_add_u32 v19, 4096, v2
    s_mul_i32 s3, s51, 81920
    s_add_u32 s3, s3, 2621440
    s_add_u32 s46, s3, s35
    s_add_u32 s47, s3, s44
    s_mul_i32 s48, s33, 81920
    s_mul_i32 s3, s51, 2560
    s_add_u32 s48, s48, s3
    s_add_u32 s48, s48, 5242880
    s_and_b32 s53, s2, 1
    s_lshl_b32 s53, s53, 1
    s_and_b32 s3, s38, 1
    s_add_u32 s53, s53, s3
    s_bfe_u32 s52, s2, 0x20001
    s_lshl_b32 s52, s52, 4
    s_lshr_b32 s3, s38, 1
    s_add_u32 s52, s52, s3
    s_waitcnt lgkmcnt(0)
    s_mov_b32 s8, s4
    s_mov_b32 s9, s5
    s_mov_b32 s10, 23068672
    s_mov_b32 s11, 0x00020000
    s_cmp_lg_u32 s51, 0
    s_cbranch_scc1 L_p2_gA
    s_lshr_b32 s37, s35, 9
    s_lshr_b32 s38, s44, 9
    s_min_u32 s3, s37, s38
    s_lshr_b32 s3, s3, 4
    s_add_u32 s37, s37, 1
    s_max_u32 s37, s37, s38
    s_lshr_b32 s37, s37, 4
    s_add_u32 s3, s3, 64
    s_add_u32 s37, s37, 64
    v_mov_b32 v8, s3
    v_writelane_b32 v8, s37, 1
    s_add_u32 s3, s3, 5
    s_add_u32 s37, s37, 5
    v_writelane_b32 v8, s3, 2
    v_writelane_b32 v8, s37, 3
    s_mul_i32 s3, s33, 20
    s_add_u32 s37, s3, 19
    s_lshr_b32 s3, s3, 7
    s_lshr_b32 s37, s37, 7
    s_add_u32 s3, s3, 74
    s_add_u32 s37, s37, 74
    v_writelane_b32 v8, s3, 4
    v_writelane_b32 v8, s37, 5
    v_mov_b32 v10, 8
    v_lshlrev_b32 v8, 8, v8
    s_mov_b32 s38, 0
    s_mov_b32 s37, 22216704
L_p2_pA:
    buffer_load_dword v9, v8, s[8:11], s37 offen sc1
    s_add_u32 s38, s38, 1
    s_waitcnt vmcnt(0)
    v_cmp_ge_u32 vcc, v9, v10
    s_cmp_eq_u64 vcc, -1
    s_cbranch_scc1 L_p2_pA_ok
    s_cmp_ge_u32 s38, 0x40000
    s_cbranch_scc1 L_p2_pA_ok
    s_sleep 2
    s_branch L_p2_pA
L_p2_pA_ok:
L_p2_gA:
    s_barrier
    s_lshl_b32 s37, s51, 11
    s_add_u32 m0, s37, 0
    s_add_u32 s38, s46, 40960
    buffer_load_dwordx4 v2, s[8:11], s46 offen sc1 lds
    s_add_u32 m0, s37, 1024
    s_lshl_b32 s37, s51, 10
    buffer_load_dwordx4 v2, s[8:11], s38 offen sc1 lds
    s_add_u32 m0, s37, 8192
    s_mul_i32 s37, s51, 2560
    buffer_load_dwordx4 v3, s[8:11], s47 offen sc1 lds
    s_add_u32 m0, s37, 12288
    s_add_u32 s38, s48, 1024
    buffer_load_dwordx4 v2, s[8:11], s48 offen sc1 lds
    s_add_u32 m0, s37, 13312
    s_add_u32 s46, s46, 327680
    buffer_load_dwordx4 v2, s[8:11], s38 offen sc1 lds
    s_add_u32 m0, s37, 14336
    s_add_u32 s38, s48, 2048
    s_mov_b64 exec, 0xffffffff
    buffer_load_dwordx4 v2, s[8:11], s38 offen sc1 lds
    s_mov_b64 exec, -1
    s_add_u32 s47, s47, 327680
    s_add_u32 s48, s48, 10240
    s_mul_i32 s49, s52, 96
    s_mul_i32 s3, s51, 24
    s_add_u32 s49, s49, s3
    s_lshl_b32 s49, s49, 10
    s_add_u32 s49, s49, 7864320
    s_mul_i32 s50, s3, 20
    s_mul_i32 s3, s53, 5
    s_add_u32 s50, s50, s3
    s_lshl_b32 s50, s50, 10
    s_add_u32 s50, s50, 14155776
    v_lshrrev_b32 v4, 2, v1
    v_mul_u32_u24 v4, 640, v4
    v_and_b32 v5, 3, v1
    v_lshl_add_u32 v4, v5, 2, v4
    v_add_u32 v4, 67584, v4
    v_mov_b32 v5, 0x3f803f80
    v_mov_b32 v6, 0
    ds_write_b32 v4, v5
    ds_write_b32 v4, v6 offset:16
    s_lshl_b32 s37, s51, 11
    s_add_u32 m0, s37, 22528
    s_add_u32 s38, s46, 40960
    buffer_load_dwordx4 v2, s[8:11], s46 offen sc1 lds
    s_add_u32 m0, s37, 23552
    s_lshl_b32 s37, s51, 10
    buffer_load_dwordx4 v2, s[8:11], s38 offen sc1 lds
    s_add_u32 m0, s37, 30720
    s_mul_i32 s37, s51, 2560
    buffer_load_dwordx4 v3, s[8:11], s47 offen sc1 lds
    s_add_u32 m0, s37, 34816
    s_add_u32 s38, s48, 1024
    buffer_load_dwordx4 v2, s[8:11], s48 offen sc1 lds
    s_add_u32 m0, s37, 35840
    s_add_u32 s46, s46, 327680
    buffer_load_dwordx4 v2, s[8:11], s38 offen sc1 lds
    s_add_u32 m0, s37, 36864
    s_add_u32 s38, s48, 2048
    s_mov_b64 exec, 0xffffffff
    buffer_load_dwordx4 v2, s[8:11], s38 offen sc1 lds
    s_mov_b64 exec, -1
    s_add_u32 s47, s47, 327680
    s_add_u32 s48, s48, 10240
    s_lshl_b32 s37, s51, 11
    s_add_u32 m0, s37, 45056
    s_add_u32 s38, s46, 40960
    buffer_load_dwordx4 v2, s[8:11], s46 offen sc1 lds
    s_add_u32 m0, s37, 46080
    s_lshl_b32 s37, s51, 10
    buffer_load_dwordx4 v2, s[8:11], s38 offen sc1 lds
    s_add_u32 m0, s37, 53248
    s_mul_i32 s37, s51, 2560
    buffer_load_dwordx4 v3, s[8:11], s47 offen sc1 lds
    s_add_u32 m0, s37, 57344
    s_add_u32 s38, s48, 1024
    buffer_load_dwordx4 v2, s[8:11], s48 offen sc1 lds
    s_add_u32 m0, s37, 58368
    s_add_u32 s46, s46, 327680
    buffer_load_dwordx4 v2, s[8:11], s38 offen sc1 lds
    s_add_u32 m0, s37, 59392
    s_add_u32 s38, s48, 2048
    s_mov_b64 exec, 0xffffffff
    buffer_load_dwordx4 v2, s[8:11], s38 offen sc1 lds
    s_mov_b64 exec, -1
    s_add_u32 s47, s47, 327680
    s_add_u32 s48, s48, 10240
    s_waitcnt vmcnt(12)
    s_waitcnt lgkmcnt(0)
    s_barrier
    s_lshr_b32 s3, s52, 3
    s_add_u32 s3, s3, 80
    s_and_b32 s37, s2, 7
    s_add_u32 s37, s37, 88
    v_mov_b32 v8, s3
    v_writelane_b32 v8, s37, 1
    v_mov_b32 v10, 12
    v_writelane_b32 v10, 32, 1
    v_lshlrev_b32 v8, 8, v8
    s_mov_b32 s38, 0
    s_mov_b32 s37, 22216704
L_p2_pB:
    buffer_load_dword v9, v8, s[8:11], s37 offen sc1
    s_add_u32 s38, s38, 1
    s_waitcnt vmcnt(0)
    v_cmp_ge_u32 vcc, v9, v10
    s_cmp_eq_u64 vcc, -1
    s_cbranch_scc1 L_p2_pB_ok
    s_cmp_ge_u32 s38, 0x40000
    s_cbranch_scc1 L_p2_pB_ok
    s_sleep 4
    s_branch L_p2_pB
L_p2_pB_ok:
    buffer_load_dwordx4 v[24:27], v2, s[8:11], s49 offen sc1
    buffer_load_dwordx4 v[28:31], v2, s[8:11], s50 offen offset:0 sc1
    buffer_load_dwordx4 v[32:35], v2, s[8:11], s50 offen offset:1024 sc1
    buffer_load_dwordx4 v[36:39], v2, s[8:11], s50 offen offset:2048 sc1
    buffer_load_dwordx4 v[40:43], v2, s[8:11], s50 offen offset:3072 sc1
    buffer_load_dwordx4 v[44:47], v19, s[8:11], s50 offen sc1
    s_add_u32 s49, s49, 1024
    s_add_u32 s50, s50, 20480
    buffer_load_dwordx4 v[48:51], v2, s[8:11], s49 offen sc1
    buffer_load_dwordx4 v[52:55], v2, s[8:11], s50 offen offset:0 sc1
    buffer_load_dwordx4 v[56:59], v2, s[8:11], s50 offen offset:1024 sc1
    buffer_load_dwordx4 v[60:63], v2, s[8:11], s50 offen offset:2048 sc1
    buffer_load_dwordx4 v[64:67], v2, s[8:11], s50 offen offset:3072 sc1
    buffer_load_dwordx4 v[68:71], v19, s[8:11], s50 offen sc1
    s_add_u32 s49, s49, 1024
    s_add_u32 s50, s50, 20480
    buffer_load_dwordx4 v[72:75], v2, s[8:11], s49 offen sc1
    buffer_load_dwordx4 v[76:79], v2, s[8:11], s50 offen offset:0 sc1
    buffer_load_dwordx4 v[80:83], v2, s[8:11], s50 offen offset:1024 sc1
    buffer_load_dwordx4 v[84:87], v2, s[8:11], s50 offen offset:2048 sc1
    buffer_load_dwordx4 v[88:91], v2, s[8:11], s50 offen offset:3072 sc1
    buffer_load_dwordx4 v[92:95], v19, s[8:11], s50 offen sc1
    s_add_u32 s49, s49, 1024
    s_add_u32 s50, s50, 20480
    s_waitcnt vmcnt(12)
    v_mfma_f32_32x32x16_bf16 v[96:111], v[28:31], v[24:27], 0
    v_mfma_f32_32x32x16_bf16 v[112:127], v[32:35], v[24:27], 0
    v_mfma_f32_32x32x16_bf16 v[128:143], v[36:39], v[24:27], 0
    v_mfma_f32_32x32x16_bf16 v[144:159], v[40:43], v[24:27], 0
    v_mfma_f32_32x32x16_bf16 v[160:175], v[44:47], v[24:27], 0
    buffer_load_dwordx4 v[24:27], v2, s[8:11], s49 offen sc1
    buffer_load_dwordx4 v[28:31], v2, s[8:11], s50 offen offset:0 sc1
    buffer_load_dwordx4 v[32:35], v2, s[8:11], s50 offen offset:1024 sc1
    buffer_load_dwordx4 v[36:39], v2, s[8:11], s50 offen offset:2048 sc1
    buffer_load_dwordx4 v[40:43], v2, s[8:11], s50 offen offset:3072 sc1
    buffer_load_dwordx4 v[44:47], v19, s[8:11], s50 offen sc1
    s_add_u32 s49, s49, 1024
    s_add_u32 s50, s50, 20480
    s_waitcnt vmcnt(12)
    v_mfma_f32_32x32x16_bf16 v[96:111], v[52:55], v[48:51], v[96:111]
    v_mfma_f32_32x32x16_bf16 v[112:127], v[56:59], v[48:51], v[112:127]
    v_mfma_f32_32x32x16_bf16 v[128:143], v[60:63], v[48:51], v[128:143]
    v_mfma_f32_32x32x16_bf16 v[144:159], v[64:67], v[48:51], v[144:159]
    v_mfma_f32_32x32x16_bf16 v[160:175], v[68:71], v[48:51], v[160:175]
    buffer_load_dwordx4 v[48:51], v2, s[8:11], s49 offen sc1
    buffer_load_dwordx4 v[52:55], v2, s[8:11], s50 offen offset:0 sc1
    buffer_load_dwordx4 v[56:59], v2, s[8:11], s50 offen offset:1024 sc1
    buffer_load_dwordx4 v[60:63], v2, s[8:11], s50 offen offset:2048 sc1
    buffer_load_dwordx4 v[64:67], v2, s[8:11], s50 offen offset:3072 sc1
    buffer_load_dwordx4 v[68:71], v19, s[8:11], s50 offen sc1
    s_add_u32 s49, s49, 1024
    s_add_u32 s50, s50, 20480
    s_waitcnt vmcnt(12)
    v_mfma_f32_32x32x16_bf16 v[96:111], v[76:79], v[72:75], v[96:111]
    v_mfma_f32_32x32x16_bf16 v[112:127], v[80:83], v[72:75], v[112:127]
    v_mfma_f32_32x32x16_bf16 v[128:143], v[84:87], v[72:75], v[128:143]
    v_mfma_f32_32x32x16_bf16 v[144:159], v[88:91], v[72:75], v[144:159]
    v_mfma_f32_32x32x16_bf16 v[160:175], v[92:95], v[72:75], v[160:175]
    buffer_load_dwordx4 v[72:75], v2, s[8:11], s49 offen sc1
    buffer_load_dwordx4 v[76:79], v2, s[8:11], s50 offen offset:0 sc1
    buffer_load_dwordx4 v[80:83], v2, s[8:11], s50 offen offset:1024 sc1
    buffer_load_dwordx4 v[84:87], v2, s[8:11], s50 offen offset:2048 sc1
    buffer_load_dwordx4 v[88:91], v2, s[8:11], s50 offen offset:3072 sc1
    buffer_load_dwordx4 v[92:95], v19, s[8:11], s50 offen sc1
    s_add_u32 s49, s49, 1024
    s_add_u32 s50, s50, 20480
    s_barrier
    s_lshl_b32 s37, s51, 11
    s_add_u32 m0, s37, 0
    s_add_u32 s38, s46, 40960
    buffer_load_dwordx4 v2, s[8:11], s46 offen sc1 lds
    s_add_u32 m0, s37, 1024
    s_lshl_b32 s37, s51, 10
    buffer_load_dwordx4 v2, s[8:11], s38 offen sc1 lds
    s_add_u32 m0, s37, 8192
    s_mul_i32 s37, s51, 2560
    buffer_load_dwordx4 v3, s[8:11], s47 offen sc1 lds
    s_add_u32 m0, s37, 12288
    s_add_u32 s38, s48, 1024
    buffer_load_dwordx4 v2, s[8:11], s48 offen sc1 lds
    s_add_u32 m0, s37, 13312
    s_add_u32 s46, s46, 327680
    buffer_load_dwordx4 v2, s[8:11], s38 offen sc1 lds
    s_add_u32 m0, s37, 14336
    s_add_u32 s38, s48, 2048
    s_mov_b64 exec, 0xffffffff
    buffer_load_dwordx4 v2, s[8:11], s38 offen sc1 lds
    s_mov_b64 exec, -1
    s_add_u32 s47, s47, 327680
    s_add_u32 s48, s48, 10240
    s_waitcnt vmcnt(18)
    v_mfma_f32_32x32x16_bf16 v[96:111], v[28:31], v[24:27], v[96:111]
    v_mfma_f32_32x32x16_bf16 v[112:127], v[32:35], v[24:27], v[112:127]
    v_mfma_f32_32x32x16_bf16 v[128:143], v[36:39], v[24:27], v[128:143]
    v_mfma_f32_32x32x16_bf16 v[144:159], v[40:43], v[24:27], v[144:159]
    v_mfma_f32_32x32x16_bf16 v[160:175], v[44:47], v[24:27], v[160:175]
    buffer_load_dwordx4 v[24:27], v2, s[8:11], s49 offen sc1
    buffer_load_dwordx4 v[28:31], v2, s[8:11], s50 offen offset:0 sc1
    buffer_load_dwordx4 v[32:35], v2, s[8:11], s50 offen offset:1024 sc1
    buffer_load_dwordx4 v[36:39], v2, s[8:11], s50 offen offset:2048 sc1
    buffer_load_dwordx4 v[40:43], v2, s[8:11], s50 offen offset:3072 sc1
    buffer_load_dwordx4 v[44:47], v19, s[8:11], s50 offen sc1
    s_add_u32 s49, s49, 1024
    s_add_u32 s50, s50, 20480
    s_waitcnt vmcnt(18)
    v_mfma_f32_32x32x16_bf16 v[96:111], v[52:55], v[48:51], v[96:111]
    v_mfma_f32_32x32x16_bf16 v[112:127], v[56:59], v[48:51], v[112:127]
    v_mfma_f32_32x32x16_bf16 v[128:143], v[60:63], v[48:51], v[128:143]
    v_mfma_f32_32x32x16_bf16 v[144:159], v[64:67], v[48:51], v[144:159]
    v_mfma_f32_32x32x16_bf16 v[160:175], v[68:71], v[48:51], v[160:175]
    buffer_load_dwordx4 v[48:51], v2, s[8:11], s49 offen sc1
    buffer_load_dwordx4 v[52:55], v2, s[8:11], s50 offen offset:0 sc1
    buffer_load_dwordx4 v[56:59], v2, s[8:11], s50 offen offset:1024 sc1
    buffer_load_dwordx4 v[60:63], v2, s[8:11], s50 offen offset:2048 sc1
    buffer_load_dwordx4 v[64:67], v2, s[8:11], s50 offen offset:3072 sc1
    buffer_load_dwordx4 v[68:71], v19, s[8:11], s50 offen sc1
    s_add_u32 s49, s49, 1024
    s_add_u32 s50, s50, 20480
    s_waitcnt vmcnt(18)
    v_mfma_f32_32x32x16_bf16 v[96:111], v[76:79], v[72:75], v[96:111]
    v_mfma_f32_32x32x16_bf16 v[112:127], v[80:83], v[72:75], v[112:127]
    v_mfma_f32_32x32x16_bf16 v[128:143], v[84:87], v[72:75], v[128:143]
    v_mfma_f32_32x32x16_bf16 v[144:159], v[88:91], v[72:75], v[144:159]
    v_mfma_f32_32x32x16_bf16 v[160:175], v[92:95], v[72:75], v[160:175]
    buffer_load_dwordx4 v[72:75], v2, s[8:11], s49 offen sc1
    buffer_load_dwordx4 v[76:79], v2, s[8:11], s50 offen offset:0 sc1
    buffer_load_dwordx4 v[80:83], v2, s[8:11], s50 offen offset:1024 sc1
    buffer_load_dwordx4 v[84:87], v2, s[8:11], s50 offen offset:2048 sc1
    buffer_load_dwordx4 v[88:91], v2, s[8:11], s50 offen offset:3072 sc1
    buffer_load_dwordx4 v[92:95], v19, s[8:11], s50 offen sc1
    s_add_u32 s49, s49, 1024
    s_add_u32 s50, s50, 20480
    s_waitcnt vmcnt(12)
    v_mfma_f32_32x32x16_bf16 v[96:111], v[28:31], v[24:27], v[96:111]
    v_mfma_f32_32x32x16_bf16 v[112:127], v[32:35], v[24:27], v[112:127]
    v_mfma_f32_32x32x16_bf16 v[128:143], v[36:39], v[24:27], v[128:143]
    v_mfma_f32_32x32x16_bf16 v[144:159], v[40:43], v[24:27], v[144:159]
    v_mfma_f32_32x32x16_bf16 v[160:175], v[44:47], v[24:27], v[160:175]
    buffer_load_dwordx4 v[24:27], v2, s[8:11], s49 offen sc1
    buffer_load_dwordx4 v[28:31], v2, s[8:11], s50 offen offset:0 sc1
    buffer_load_dwordx4 v[32:35], v2, s[8:11], s50 offen offset:1024 sc1
    buffer_load_dwordx4 v[36:39], v2, s[8:11], s50 offen offset:2048 sc1
    buffer_load_dwordx4 v[40:43], v2, s[8:11], s50 offen offset:3072 sc1
    buffer_load_dwordx4 v[44:47], v19, s[8:11], s50 offen sc1
    s_add_u32 s49, s49, 1024
    s_add_u32 s50, s50, 20480
    s_barrier
    s_lshl_b32 s37, s51, 11
    s_add_u32 m0, s37, 22528
    s_add_u32 s38, s46, 40960
    buffer_load_dwordx4 v2, s[8:11], s46 offen sc1 lds
    s_add_u32 m0, s37, 23552
    s_lshl_b32 s37, s51, 10
    buffer_load_dwordx4 v2, s[8:11], s38 offen sc1 lds
    s_add_u32 m0, s37, 30720
    s_mul_i32 s37, s51, 2560
    buffer_load_dwordx4 v3, s[8:11], s47 offen sc1 lds
    s_add_u32 m0, s37, 34816
    s_add_u32 s38, s48, 1024
    buffer_load_dwordx4 v2, s[8:11], s48 offen sc1 lds
    s_add_u32 m0, s37, 35840
    s_add_u32 s46, s46, 327680
    buffer_load_dwordx4 v2, s[8:11], s38 offen sc1 lds
    s_add_u32 m0, s37, 36864
    s_add_u32 s38, s48, 2048
    s_mov_b64 exec, 0xffffffff
    buffer_load_dwordx4 v2, s[8:11], s38 offen sc1 lds
    s_mov_b64 exec, -1
    s_add_u32 s47, s47, 327680
    s_add_u32 s48, s48, 10240
    s_waitcnt vmcnt(18)
    v_mfma_f32_32x32x16_bf16 v[96:111], v[52:55], v[48:51], v[96:111]
    v_mfma_f32_32x32x16_bf16 v[112:127], v[56:59], v[48:51], v[112:127]
    v_mfma_f32_32x32x16_bf16 v[128:143], v[60:63], v[48:51], v[128:143]
    v_mfma_f32_32x32x16_bf16 v[144:159], v[64:67], v[48:51], v[144:159]
    v_mfma_f32_32x32x16_bf16 v[160:175], v[68:71], v[48:51], v[160:175]
    buffer_load_dwordx4 v[48:51], v2, s[8:11], s49 offen sc1
    buffer_load_dwordx4 v[52:55], v2, s[8:11], s50 offen offset:0 sc1
    buffer_load_dwordx4 v[56:59], v2, s[8:11], s50 offen offset:1024 sc1
    buffer_load_dwordx4 v[60:63], v2, s[8:11], s50 offen offset:2048 sc1
    buffer_load_dwordx4 v[64:67], v2, s[8:11], s50 offen offset:3072 sc1
    buffer_load_dwordx4 v[68:71], v19, s[8:11], s50 offen sc1
    s_add_u32 s49, s49, 1024
    s_add_u32 s50, s50, 20480
    s_waitcnt vmcnt(18)
    v_mfma_f32_32x32x16_bf16 v[96:111], v[76:79], v[72:75], v[96:111]
    v_mfma_f32_32x32x16_bf16 v[112:127], v[80:83], v[72:75], v[112:127]
    v_mfma_f32_32x32x16_bf16 v[128:143], v[84:87], v[72:75], v[128:143]
    v_mfma_f32_32x32x16_bf16 v[144:159], v[88:91], v[72:75], v[144:159]
    v_mfma_f32_32x32x16_bf16 v[160:175], v[92:95], v[72:75], v[160:175]
    buffer_load_dwordx4 v[72:75], v2, s[8:11], s49 offen sc1
    buffer_load_dwordx4 v[76:79], v2, s[8:11], s50 offen offset:0 sc1
    buffer_load_dwordx4 v[80:83], v2, s[8:11], s50 offen offset:1024 sc1
    buffer_load_dwordx4 v[84:87], v2, s[8:11], s50 offen offset:2048 sc1
    buffer_load_dwordx4 v[88:91], v2, s[8:11], s50 offen offset:3072 sc1
    buffer_load_dwordx4 v[92:95], v19, s[8:11], s50 offen sc1
    s_add_u32 s49, s49, 1024
    s_add_u32 s50, s50, 20480
    s_waitcnt vmcnt(18)
    v_mfma_f32_32x32x16_bf16 v[96:111], v[28:31], v[24:27], v[96:111]
    v_mfma_f32_32x32x16_bf16 v[112:127], v[32:35], v[24:27], v[112:127]
    v_mfma_f32_32x32x16_bf16 v[128:143], v[36:39], v[24:27], v[128:143]
    v_mfma_f32_32x32x16_bf16 v[144:159], v[40:43], v[24:27], v[144:159]
    v_mfma_f32_32x32x16_bf16 v[160:175], v[44:47], v[24:27], v[160:175]
    buffer_load_dwordx4 v[24:27], v2, s[8:11], s49 offen sc1
    buffer_load_dwordx4 v[28:31], v2, s[8:11], s50 offen offset:0 sc1
    buffer_load_dwordx4 v[32:35], v2, s[8:11], s50 offen offset:1024 sc1
    buffer_load_dwordx4 v[36:39], v2, s[8:11], s50 offen offset:2048 sc1
    buffer_load_dwordx4 v[40:43], v2, s[8:11], s50 offen offset:3072 sc1
    buffer_load_dwordx4 v[44:47], v19, s[8:11], s50 offen sc1
    s_add_u32 s49, s49, 1024
    s_add_u32 s50, s50, 20480
    s_waitcnt vmcnt(12)
    v_mfma_f32_32x32x16_bf16 v[96:111], v[52:55], v[48:51], v[96:111]
    v_mfma_f32_32x32x16_bf16 v[112:127], v[56:59], v[48:51], v[112:127]
    v_mfma_f32_32x32x16_bf16 v[128:143], v[60:63], v[48:51], v[128:143]
    v_mfma_f32_32x32x16_bf16 v[144:159], v[64:67], v[48:51], v[144:159]
    v_mfma_f32_32x32x16_bf16 v[160:175], v[68:71], v[48:51], v[160:175]
    buffer_load_dwordx4 v[48:51], v2, s[8:11], s49 offen sc1
    buffer_load_dwordx4 v[52:55], v2, s[8:11], s50 offen offset:0 sc1
    buffer_load_dwordx4 v[56:59], v2, s[8:11], s50 offen offset:1024 sc1
    buffer_load_dwordx4 v[60:63], v2, s[8:11], s50 offen offset:2048 sc1
    buffer_load_dwordx4 v[64:67], v2, s[8:11], s50 offen offset:3072 sc1
    buffer_load_dwordx4 v[68:71], v19, s[8:11], s50 offen sc1
    s_add_u32 s49, s49, 1024
    s_add_u32 s50, s50, 20480
    s_barrier
    s_lshl_b32 s37, s51, 11
    s_add_u32 m0, s37, 45056
    s_add_u32 s38, s46, 40960
    buffer_load_dwordx4 v2, s[8:11], s46 offen sc1 lds
    s_add_u32 m0, s37, 46080
    s_lshl_b32 s37, s51, 10
    buffer_load_dwordx4 v2, s[8:11], s38 offen sc1 lds
    s_add_u32 m0, s37, 53248
    s_mul_i32 s37, s51, 2560
    buffer_load_dwordx4 v3, s[8:11], s47 offen sc1 lds
    s_add_u32 m0, s37, 57344
    s_add_u32 s38, s48, 1024
    buffer_load_dwordx4 v2, s[8:11], s48 offen sc1 lds
    s_add_u32 m0, s37, 58368
    s_add_u32 s46, s46, 327680
    buffer_load_dwordx4 v2, s[8:11], s38 offen sc1 lds
    s_add_u32 m0, s37, 59392
    s_add_u32 s38, s48, 2048
    s_mov_b64 exec, 0xffffffff
    buffer_load_dwordx4 v2, s[8:11], s38 offen sc1 lds
    s_mov_b64 exec, -1
    s_add_u32 s47, s47, 327680
    s_add_u32 s48, s48, 10240
    s_waitcnt vmcnt(18)
    v_mfma_f32_32x32x16_bf16 v[96:111], v[76:79], v[72:75], v[96:111]
    v_mfma_f32_32x32x16_bf16 v[112:127], v[80:83], v[72:75], v[112:127]
    v_mfma_f32_32x32x16_bf16 v[128:143], v[84:87], v[72:75], v[128:143]
    v_mfma_f32_32x32x16_bf16 v[144:159], v[88:91], v[72:75], v[144:159]
    v_mfma_f32_32x32x16_bf16 v[160:175], v[92:95], v[72:75], v[160:175]
    buffer_load_dwordx4 v[72:75], v2, s[8:11], s49 offen sc1
    buffer_load_dwordx4 v[76:79], v2, s[8:11], s50 offen offset:0 sc1
    buffer_load_dwordx4 v[80:83], v2, s[8:11], s50 offen offset:1024 sc1
    buffer_load_dwordx4 v[84:87], v2, s[8:11], s50 offen offset:2048 sc1
    buffer_load_dwordx4 v[88:91], v2, s[8:11], s50 offen offset:3072 sc1
    buffer_load_dwordx4 v[92:95], v19, s[8:11], s50 offen sc1
    s_add_u32 s49, s49, 1024
    s_add_u32 s50, s50, 20480
    s_waitcnt vmcnt(18)
    v_mfma_f32_32x32x16_bf16 v[96:111], v[28:31], v[24:27], v[96:111]
    v_mfma_f32_32x32x16_bf16 v[112:127], v[32:35], v[24:27], v[112:127]
    v_mfma_f32_32x32x16_bf16 v[128:143], v[36:39], v[24:27], v[128:143]
    v_mfma_f32_32x32x16_bf16 v[144:159], v[40:43], v[24:27], v[144:159]
    v_mfma_f32_32x32x16_bf16 v[160:175], v[44:47], v[24:27], v[160:175]
    buffer_load_dwordx4 v[24:27], v2, s[8:11], s49 offen sc1
    buffer_load_dwordx4 v[28:31], v2, s[8:11], s50 offen offset:0 sc1
    buffer_load_dwordx4 v[32:35], v2, s[8:11], s50 offen offset:1024 sc1
    buffer_load_dwordx4 v[36:39], v2, s[8:11], s50 offen offset:2048 sc1
    buffer_load_dwordx4 v[40:43], v2, s[8:11], s50 offen offset:3072 sc1
    buffer_load_dwordx4 v[44:47], v19, s[8:11], s50 offen sc1
    s_add_u32 s49, s49, 1024
    s_add_u32 s50, s50, 20480
    s_waitcnt vmcnt(18)
    v_mfma_f32_32x32x16_bf16 v[96:111], v[52:55], v[48:51], v[96:111]
    v_mfma_f32_32x32x16_bf16 v[112:127], v[56:59], v[48:51], v[112:127]
    v_mfma_f32_32x32x16_bf16 v[128:143], v[60:63], v[48:51], v[128:143]
    v_mfma_f32_32x32x16_bf16 v[144:159], v[64:67], v[48:51], v[144:159]
    v_mfma_f32_32x32x16_bf16 v[160:175], v[68:71], v[48:51], v[160:175]
    buffer_load_dwordx4 v[48:51], v2, s[8:11], s49 offen sc1
    buffer_load_dwordx4 v[52:55], v2, s[8:11], s50 offen offset:0 sc1
    buffer_load_dwordx4 v[56:59], v2, s[8:11], s50 offen offset:1024 sc1
    buffer_load_dwordx4 v[60:63], v2, s[8:11], s50 offen offset:2048 sc1
    buffer_load_dwordx4 v[64:67], v2, s[8:11], s50 offen offset:3072 sc1
    buffer_load_dwordx4 v[68:71], v19, s[8:11], s50 offen sc1
    s_add_u32 s49, s49, 1024
    s_add_u32 s50, s50, 20480
    s_waitcnt vmcnt(12)
    v_mfma_f32_32x32x16_bf16 v[96:111], v[76:79], v[72:75], v[96:111]
    v_mfma_f32_32x32x16_bf16 v[112:127], v[80:83], v[72:75], v[112:127]
    v_mfma_f32_32x32x16_bf16 v[128:143], v[84:87], v[72:75], v[128:143]
    v_mfma_f32_32x32x16_bf16 v[144:159], v[88:91], v[72:75], v[144:159]
    v_mfma_f32_32x32x16_bf16 v[160:175], v[92:95], v[72:75], v[160:175]
    buffer_load_dwordx4 v[72:75], v2, s[8:11], s49 offen sc1
    buffer_load_dwordx4 v[76:79], v2, s[8:11], s50 offen offset:0 sc1
    buffer_load_dwordx4 v[80:83], v2, s[8:11], s50 offen offset:1024 sc1
    buffer_load_dwordx4 v[84:87], v2, s[8:11], s50 offen offset:2048 sc1
    buffer_load_dwordx4 v[88:91], v2, s[8:11], s50 offen offset:3072 sc1
    buffer_load_dwordx4 v[92:95], v19, s[8:11], s50 offen sc1
    s_add_u32 s49, s49, 1024
    s_add_u32 s50, s50, 20480
    s_barrier
    s_lshl_b32 s37, s51, 11
    s_add_u32 m0, s37, 0
    s_add_u32 s38, s46, 40960
    buffer_load_dwordx4 v2, s[8:11], s46 offen sc1 lds
    s_add_u32 m0, s37, 1024
    s_lshl_b32 s37, s51, 10
    buffer_load_dwordx4 v2, s[8:11], s38 offen sc1 lds
    s_add_u32 m0, s37, 8192
    s_mul_i32 s37, s51, 2560
    buffer_load_dwordx4 v3, s[8:11], s47 offen sc1 lds
    s_add_u32 m0, s37, 12288
    s_add_u32 s38, s48, 1024
    buffer_load_dwordx4 v2, s[8:11], s48 offen sc1 lds
    s_add_u32 m0, s37, 13312
    s_add_u32 s46, s46, 327680
    buffer_load_dwordx4 v2, s[8:11], s38 offen sc1 lds
    s_add_u32 m0, s37, 14336
    s_add_u32 s38, s48, 2048
    s_mov_b64 exec, 0xffffffff
    buffer_load_dwordx4 v2, s[8:11], s38 offen sc1 lds
    s_mov_b64 exec, -1
    s_add_u32 s47, s47, 327680
    s_add_u32 s48, s48, 10240
    s_waitcnt vmcnt(18)
    v_mfma_f32_32x32x16_bf16 v[96:111], v[28:31], v[24:27], v[96:111]
    v_mfma_f32_32x32x16_bf16 v[112:127], v[32:35], v[24:27], v[112:127]
    v_mfma_f32_32x32x16_bf16 v[128:143], v[36:39], v[24:27], v[128:143]
    v_mfma_f32_32x32x16_bf16 v[144:159], v[40:43], v[24:27], v[144:159]
    v_mfma_f32_32x32x16_bf16 v[160:175], v[44:47], v[24:27], v[160:175]
    buffer_load_dwordx4 v[24:27], v2, s[8:11], s49 offen sc1
    buffer_load_dwordx4 v[28:31], v2, s[8:11], s50 offen offset:0 sc1
    buffer_load_dwordx4 v[32:35], v2, s[8:11], s50 offen offset:1024 sc1
    buffer_load_dwordx4 v[36:39], v2, s[8:11], s50 offen offset:2048 sc1
    buffer_load_dwordx4 v[40:43], v2, s[8:11], s50 offen offset:3072 sc1
    buffer_load_dwordx4 v[44:47], v19, s[8:11], s50 offen sc1
    s_add_u32 s49, s49, 1024
    s_add_u32 s50, s50, 20480
    s_waitcnt vmcnt(18)
    v_mfma_f32_32x32x16_bf16 v[96:111], v[52:55], v[48:51], v[96:111]
    v_mfma_f32_32x32x16_bf16 v[112:127], v[56:59], v[48:51], v[112:127]
    v_mfma_f32_32x32x16_bf16 v[128:143], v[60:63], v[48:51], v[128:143]
    v_mfma_f32_32x32x16_bf16 v[144:159], v[64:67], v[48:51], v[144:159]
    v_mfma_f32_32x32x16_bf16 v[160:175], v[68:71], v[48:51], v[160:175]
    buffer_load_dwordx4 v[48:51], v2, s[8:11], s49 offen sc1
    buffer_load_dwordx4 v[52:55], v2, s[8:11], s50 offen offset:0 sc1
    buffer_load_dwordx4 v[56:59], v2, s[8:11], s50 offen offset:1024 sc1
    buffer_load_dwordx4 v[60:63], v2, s[8:11], s50 offen offset:2048 sc1
    buffer_load_dwordx4 v[64:67], v2, s[8:11], s50 offen offset:3072 sc1
    buffer_load_dwordx4 v[68:71], v19, s[8:11], s50 offen sc1
    s_add_u32 s49, s49, 1024
    s_add_u32 s50, s50, 20480
    s_waitcnt vmcnt(18)
    v_mfma_f32_32x32x16_bf16 v[96:111], v[76:79], v[72:75], v[96:111]
    v_mfma_f32_32x32x16_bf16 v[112:127], v[80:83], v[72:75], v[112:127]
    v_mfma_f32_32x32x16_bf16 v[128:143], v[84:87], v[72:75], v[128:143]
    v_mfma_f32_32x32x16_bf16 v[144:159], v[88:91], v[72:75], v[144:159]
    v_mfma_f32_32x32x16_bf16 v[160:175], v[92:95], v[72:75], v[160:175]
    buffer_load_dwordx4 v[72:75], v2, s[8:11], s49 offen sc1
    buffer_load_dwordx4 v[76:79], v2, s[8:11], s50 offen offset:0 sc1
    buffer_load_dwordx4 v[80:83], v2, s[8:11], s50 offen offset:1024 sc1
    buffer_load_dwordx4 v[84:87], v2, s[8:11], s50 offen offset:2048 sc1
    buffer_load_dwordx4 v[88:91], v2, s[8:11], s50 offen offset:3072 sc1
    buffer_load_dwordx4 v[92:95], v19, s[8:11], s50 offen sc1
    s_add_u32 s49, s49, 1024
    s_add_u32 s50, s50, 20480
    s_waitcnt vmcnt(12)
    v_mfma_f32_32x32x16_bf16 v[96:111], v[28:31], v[24:27], v[96:111]
    v_mfma_f32_32x32x16_bf16 v[112:127], v[32:35], v[24:27], v[112:127]
    v_mfma_f32_32x32x16_bf16 v[128:143], v[36:39], v[24:27], v[128:143]
    v_mfma_f32_32x32x16_bf16 v[144:159], v[40:43], v[24:27], v[144:159]
    v_mfma_f32_32x32x16_bf16 v[160:175], v[44:47], v[24:27], v[160:175]
    buffer_load_dwordx4 v[24:27], v2, s[8:11], s49 offen sc1
    buffer_load_dwordx4 v[28:31], v2, s[8:11], s50 offen offset:0 sc1
    buffer_load_dwordx4 v[32:35], v2, s[8:11], s50 offen offset:1024 sc1
    buffer_load_dwordx4 v[36:39], v2, s[8:11], s50 offen offset:2048 sc1
    buffer_load_dwordx4 v[40:43], v2, s[8:11], s50 offen offset:3072 sc1
    buffer_load_dwordx4 v[44:47], v19, s[8:11], s50 offen sc1
    s_add_u32 s49, s49, 1024
    s_add_u32 s50, s50, 20480
    s_barrier
    s_lshl_b32 s37, s51, 11
    s_add_u32 m0, s37, 22528
    s_add_u32 s38, s46, 40960
    buffer_load_dwordx4 v2, s[8:11], s46 offen sc1 lds
    s_add_u32 m0, s37, 23552
    s_lshl_b32 s37, s51, 10
    buffer_load_dwordx4 v2, s[8:11], s38 offen sc1 lds
    s_add_u32 m0, s37, 30720
    s_mul_i32 s37, s51, 2560
    buffer_load_dwordx4 v3, s[8:11], s47 offen sc1 lds
    s_add_u32 m0, s37, 34816
    s_add_u32 s38, s48, 1024
    buffer_load_dwordx4 v2, s[8:11], s48 offen sc1 lds
    s_add_u32 m0, s37, 35840
    s_add_u32 s46, s46, 327680
    buffer_load_dwordx4 v2, s[8:11], s38 offen sc1 lds
    s_add_u32 m0, s37, 36864
    s_add_u32 s38, s48, 2048
    s_mov_b64 exec, 0xffffffff
    buffer_load_dwordx4 v2, s[8:11], s38 offen sc1 lds
    s_mov_b64 exec, -1
    s_add_u32 s47, s47, 327680
    s_add_u32 s48, s48, 10240
    s_waitcnt vmcnt(18)
    v_mfma_f32_32x32x16_bf16 v[96:111], v[52:55], v[48:51], v[96:111]
    v_mfma_f32_32x32x16_bf16 v[112:127], v[56:59], v[48:51], v[112:127]
    v_mfma_f32_32x32x16_bf16 v[128:143], v[60:63], v[48:51], v[128:143]
    v_mfma_f32_32x32x16_bf16 v[144:159], v[64:67], v[48:51], v[144:159]
    v_mfma_f32_32x32x16_bf16 v[160:175], v[68:71], v[48:51], v[160:175]
    buffer_load_dwordx4 v[48:51], v2, s[8:11], s49 offen sc1
    buffer_load_dwordx4 v[52:55], v2, s[8:11], s50 offen offset:0 sc1
    buffer_load_dwordx4 v[56:59], v2, s[8:11], s50 offen offset:1024 sc1
    buffer_load_dwordx4 v[60:63], v2, s[8:11], s50 offen offset:2048 sc1
    buffer_load_dwordx4 v[64:67], v2, s[8:11], s50 offen offset:3072 sc1
    buffer_load_dwordx4 v[68:71], v19, s[8:11], s50 offen sc1
    s_add_u32 s49, s49, 1024
    s_add_u32 s50, s50, 20480
    s_waitcnt vmcnt(18)
    v_mfma_f32_32x32x16_bf16 v[96:111], v[76:79], v[72:75], v[96:111]
    v_mfma_f32_32x32x16_bf16 v[112:127], v[80:83], v[72:75], v[112:127]
    v_mfma_f32_32x32x16_bf16 v[128:143], v[84:87], v[72:75], v[128:143]
    v_mfma_f32_32x32x16_bf16 v[144:159], v[88:91], v[72:75], v[144:159]
    v_mfma_f32_32x32x16_bf16 v[160:175], v[92:95], v[72:75], v[160:175]
    buffer_load_dwordx4 v[72:75], v2, s[8:11], s49 offen sc1
    buffer_load_dwordx4 v[76:79], v2, s[8:11], s50 offen offset:0 sc1
    buffer_load_dwordx4 v[80:83], v2, s[8:11], s50 offen offset:1024 sc1
    buffer_load_dwordx4 v[84:87], v2, s[8:11], s50 offen offset:2048 sc1
    buffer_load_dwordx4 v[88:91], v2, s[8:11], s50 offen offset:3072 sc1
    buffer_load_dwordx4 v[92:95], v19, s[8:11], s50 offen sc1
    s_add_u32 s49, s49, 1024
    s_add_u32 s50, s50, 20480
    s_waitcnt vmcnt(18)
    v_mfma_f32_32x32x16_bf16 v[96:111], v[28:31], v[24:27], v[96:111]
    v_mfma_f32_32x32x16_bf16 v[112:127], v[32:35], v[24:27], v[112:127]
    v_mfma_f32_32x32x16_bf16 v[128:143], v[36:39], v[24:27], v[128:143]
    v_mfma_f32_32x32x16_bf16 v[144:159], v[40:43], v[24:27], v[144:159]
    v_mfma_f32_32x32x16_bf16 v[160:175], v[44:47], v[24:27], v[160:175]
    s_waitcnt vmcnt(6)
    v_mfma_f32_32x32x16_bf16 v[96:111], v[52:55], v[48:51], v[96:111]
    v_mfma_f32_32x32x16_bf16 v[112:127], v[56:59], v[48:51], v[112:127]
    v_mfma_f32_32x32x16_bf16 v[128:143], v[60:63], v[48:51], v[128:143]
    v_mfma_f32_32x32x16_bf16 v[144:159], v[64:67], v[48:51], v[144:159]
    v_mfma_f32_32x32x16_bf16 v[160:175], v[68:71], v[48:51], v[160:175]
    s_waitcnt vmcnt(0)
    v_mfma_f32_32x32x16_bf16 v[96:111], v[76:79], v[72:75], v[96:111]
    v_mfma_f32_32x32x16_bf16 v[112:127], v[80:83], v[72:75], v[112:127]
    v_mfma_f32_32x32x16_bf16 v[128:143], v[84:87], v[72:75], v[128:143]
    v_mfma_f32_32x32x16_bf16 v[144:159], v[88:91], v[72:75], v[144:159]
    v_mfma_f32_32x32x16_bf16 v[160:175], v[92:95], v[72:75], v[160:175]
    v_and_b32 v4, 31, v1
    v_lshrrev_b32 v5, 5, v1
    v_mul_u32_u24 v4, 656, v4
    v_lshl_add_u32 v4, v5, 4, v4
    s_mul_i32 s37, s51, 20992
    s_add_u32 s37, s37, 77824
    v_add_u32 v4, s37, v4
    s_nop 6
    ds_write_b128 v4, v[96:99] offset:0
    ds_write_b128 v4, v[100:103] offset:32
    ds_write_b128 v4, v[104:107] offset:64
    ds_write_b128 v4, v[108:111] offset:96
    ds_write_b128 v4, v[112:115] offset:128
    ds_write_b128 v4, v[116:119] offset:160
    ds_write_b128 v4, v[120:123] offset:192
    ds_write_b128 v4, v[124:127] offset:224
    ds_write_b128 v4, v[128:131] offset:256
    ds_write_b128 v4, v[132:135] offset:288
    ds_write_b128 v4, v[136:139] offset:320
    ds_write_b128 v4, v[140:143] offset:352
    ds_write_b128 v4, v[144:147] offset:384
    ds_write_b128 v4, v[148:151] offset:416
    ds_write_b128 v4, v[152:155] offset:448
    ds_write_b128 v4, v[156:159] offset:480
    ds_write_b128 v4, v[160:163] offset:512
    ds_write_b128 v4, v[164:167] offset:544
    ds_write_b128 v4, v[168:171] offset:576
    ds_write_b128 v4, v[172:175] offset:608
    s_waitcnt lgkmcnt(0)
    s_barrier
    v_and_b32 v4, 31, v1
    v_lshrrev_b32 v5, 5, v1
    s_mov_b32 s16, s6
    s_mov_b32 s17, s7
    s_mov_b32 s18, 2621440
    s_mov_b32 s19, 0x00020000
    s_mov_b32 s20, s12
    s_mov_b32 s21, s13
    s_mov_b32 s22, 2621440
    s_mov_b32 s23, 0x00020000
    v_mul_u32_u24 v12, 1280, v4
    v_lshl_add_u32 v13, v5, 4, v12
    v_lshl_add_u32 v12, v5, 3, v12
    v_mul_u32_u24 v15, 656, v4
    v_lshl_add_u32 v15, v5, 4, v15
    s_mul_i32 s55, s52, 40960
    s_mul_i32 s3, s53, 320
    s_add_u32 s55, s55, s3
    s_lshl_b32 s3, s51, 4
    s_add_u32 s56, s55, s3
    s_add_u32 s56, s56, 256
    s_lshl_b32 s3, s51, 6
    s_add_u32 s55, s55, s3
    buffer_load_dwordx2 v[236:237], v12, s[16:19], s55 offen offset:0
    buffer_load_dwordx2 v[238:239], v12, s[16:19], s55 offen offset:16
    buffer_load_dwordx2 v[240:241], v12, s[16:19], s55 offen offset:32
    buffer_load_dwordx2 v[242:243], v12, s[16:19], s55 offen offset:48
    buffer_load_dwordx2 v[244:245], v12, s[16:19], s56 offen
    s_add_u32 s3, s51, 0
    s_and_b32 s3, s3, 3
    s_mul_i32 s50, s3, 204800
    s_mul_i32 s37, s53, 5
    s_add_u32 s37, s37, s51
    s_lshl_b32 s37, s37, 10
    s_add_u32 s50, s50, s37
    s_add_u32 s50, s50, 16121856
    s_mul_i32 s3, s3, 10240
    s_add_u32 s3, s3, 40960
    v_add_u32 v4, s3, v2
    buffer_load_dwordx4 v[24:27], v2, s[8:11], s50 offen sc1
    s_add_u32 s50, s50, 20480
    buffer_load_dwordx4 v[28:31], v2, s[8:11], s50 offen sc1
    s_add_u32 s50, s50, 20480
    buffer_load_dwordx4 v[32:35], v2, s[8:11], s50 offen sc1
    s_add_u32 s50, s50, 20480
    buffer_load_dwordx4 v[36:39], v2, s[8:11], s50 offen sc1
    s_add_u32 s50, s50, 20480
    buffer_load_dwordx4 v[40:43], v2, s[8:11], s50 offen sc1
    s_add_u32 s50, s50, 20480
    buffer_load_dwordx4 v[44:47], v2, s[8:11], s50 offen sc1
    s_add_u32 s50, s50, 20480
    buffer_load_dwordx4 v[48:51], v2, s[8:11], s50 offen sc1
    s_add_u32 s50, s50, 20480
    buffer_load_dwordx4 v[52:55], v2, s[8:11], s50 offen sc1
    s_add_u32 s50, s50, 20480
    buffer_load_dwordx4 v[56:59], v2, s[8:11], s50 offen sc1
    s_add_u32 s50, s50, 20480
    buffer_load_dwordx4 v[60:63], v2, s[8:11], s50 offen sc1
    s_add_u32 s3, s51, 1
    s_and_b32 s3, s3, 3
    s_mul_i32 s50, s3, 204800
    s_mul_i32 s37, s53, 5
    s_add_u32 s37, s37, s51
    s_lshl_b32 s37, s37, 10
    s_add_u32 s50, s50, s37
    s_add_u32 s50, s50, 16121856
    s_mul_i32 s3, s3, 10240
    s_add_u32 s3, s3, 40960
    v_add_u32 v5, s3, v2
    buffer_load_dwordx4 v[64:67], v2, s[8:11], s50 offen sc1
    s_add_u32 s50, s50, 20480
    buffer_load_dwordx4 v[68:71], v2, s[8:11], s50 offen sc1
    s_add_u32 s50, s50, 20480
    buffer_load_dwordx4 v[72:75], v2, s[8:11], s50 offen sc1
    s_add_u32 s50, s50, 20480
    buffer_load_dwordx4 v[76:79], v2, s[8:11], s50 offen sc1
    s_add_u32 s50, s50, 20480
    buffer_load_dwordx4 v[80:83], v2, s[8:11], s50 offen sc1
    s_add_u32 s50, s50, 20480
    buffer_load_dwordx4 v[84:87], v2, s[8:11], s50 offen sc1
    s_add_u32 s50, s50, 20480
    buffer_load_dwordx4 v[88:91], v2, s[8:11], s50 offen sc1
    s_add_u32 s50, s50, 20480
    buffer_load_dwordx4 v[92:95], v2, s[8:11], s50 offen sc1
    s_add_u32 s50, s50, 20480
    buffer_load_dwordx4 v[96:99], v2, s[8:11], s50 offen sc1
    s_add_u32 s50, s50, 20480
    buffer_load_dwordx4 v[100:103], v2, s[8:11], s50 offen sc1
    s_barrier
    s_add_u32 s3, s51, 2
    s_and_b32 s3, s3, 3
    s_mul_i32 s50, s3, 204800
    s_mul_i32 s37, s53, 5
    s_add_u32 s37, s37, s51
    s_lshl_b32 s37, s37, 10
    s_add_u32 s50, s50, s37
    s_add_u32 s50, s50, 16121856
    s_mul_i32 s3, s3, 10240
    s_add_u32 s3, s3, 40960
    v_add_u32 v6, s3, v2
    buffer_load_dwordx4 v[104:107], v2, s[8:11], s50 offen sc1
    s_add_u32 s50, s50, 20480
    buffer_load_dwordx4 v[108:111], v2, s[8:11], s50 offen sc1
    s_add_u32 s50, s50, 20480
    buffer_load_dwordx4 v[112:115], v2, s[8:11], s50 offen sc1
    s_add_u32 s50, s50, 20480
    buffer_load_dwordx4 v[116:119], v2, s[8:11], s50 offen sc1
    s_add_u32 s50, s50, 20480
    buffer_load_dwordx4 v[120:123], v2, s[8:11], s50 offen sc1
    s_add_u32 s50, s50, 20480
    buffer_load_dwordx4 v[124:127], v2, s[8:11], s50 offen sc1
    s_add_u32 s50, s50, 20480
    buffer_load_dwordx4 v[128:131], v2, s[8:11], s50 offen sc1
    s_add_u32 s50, s50, 20480
    buffer_load_dwordx4 v[132:135], v2, s[8:11], s50 offen sc1
    s_add_u32 s50, s50, 20480
    buffer_load_dwordx4 v[136:139], v2, s[8:11], s50 offen sc1
    s_add_u32 s50, s50, 20480
    buffer_load_dwordx4 v[140:143], v2, s[8:11], s50 offen sc1
    s_add_u32 s3, s51, 3
    s_and_b32 s3, s3, 3
    s_mul_i32 s50, s3, 204800
    s_mul_i32 s37, s53, 5
    s_add_u32 s37, s37, s51
    s_lshl_b32 s37, s37, 10
    s_add_u32 s50, s50, s37
    s_add_u32 s50, s50, 16121856
    s_mul_i32 s3, s3, 10240
    s_add_u32 s3, s3, 40960
    v_add_u32 v7, s3, v2
    buffer_load_dwordx4 v[144:147], v2, s[8:11], s50 offen sc1
    s_add_u32 s50, s50, 20480
    buffer_load_dwordx4 v[148:151], v2, s[8:11], s50 offen sc1
    s_add_u32 s50, s50, 20480
    buffer_load_dwordx4 v[152:155], v2, s[8:11], s50 offen sc1
    s_add_u32 s50, s50, 20480
    buffer_load_dwordx4 v[156:159], v2, s[8:11], s50 offen sc1
    s_add_u32 s50, s50, 20480
    buffer_load_dwordx4 v[160:163], v2, s[8:11], s50 offen sc1
    s_add_u32 s50, s50, 20480
    buffer_load_dwordx4 v[164:167], v2, s[8:11], s50 offen sc1
    s_add_u32 s50, s50, 20480
    buffer_load_dwordx4 v[168:171], v2, s[8:11], s50 offen sc1
    s_add_u32 s50, s50, 20480
    buffer_load_dwordx4 v[172:175], v2, s[8:11], s50 offen sc1
    s_add_u32 s50, s50, 20480
    buffer_load_dwordx4 v[176:179], v2, s[8:11], s50 offen sc1
    s_add_u32 s50, s50, 20480
    buffer_load_dwordx4 v[180:183], v2, s[8:11], s50 offen sc1
    s_barrier
    s_mul_i32 s50, s51, 204800
    s_mul_i32 s37, s53, 5
    s_add_u32 s37, s37, 4
    s_lshl_b32 s37, s37, 10
    s_add_u32 s50, s50, s37
    s_add_u32 s50, s50, 16121856
    s_mul_i32 s37, s51, 10240
    s_add_u32 s37, s37, 0
    v_add_u32 v14, s37, v2
    s_add_u32 m0, s37, 0
    s_nop 0
    buffer_load_dwordx4 v2, s[8:11], s50 offen sc1 lds
    s_add_u32 s50, s50, 20480
    s_add_u32 m0, s37, 1024
    s_nop 0
    buffer_load_dwordx4 v2, s[8:11], s50 offen sc1 lds
    s_add_u32 s50, s50, 20480
    s_add_u32 m0, s37, 2048
    s_nop 0
    buffer_load_dwordx4 v2, s[8:11], s50 offen sc1 lds
    s_add_u32 s50, s50, 20480
    s_add_u32 m0, s37, 3072
    s_nop 0
    buffer_load_dwordx4 v2, s[8:11], s50 offen sc1 lds
    s_add_u32 s50, s50, 20480
    s_add_u32 m0, s37, 4096
    s_nop 0
    buffer_load_dwordx4 v2, s[8:11], s50 offen sc1 lds
    s_add_u32 s50, s50, 20480
    s_add_u32 m0, s37, 5120
    s_nop 0
    buffer_load_dwordx4 v2, s[8:11], s50 offen sc1 lds
    s_add_u32 s50, s50, 20480
    s_add_u32 m0, s37, 6144
    s_nop 0
    buffer_load_dwordx4 v2, s[8:11], s50 offen sc1 lds
    s_add_u32 s50, s50, 20480
    s_add_u32 m0, s37, 7168
    s_nop 0
    buffer_load_dwordx4 v2, s[8:11], s50 offen sc1 lds
    s_add_u32 s50, s50, 20480
    s_add_u32 m0, s37, 8192
    s_nop 0
    buffer_load_dwordx4 v2, s[8:11], s50 offen sc1 lds
    s_add_u32 s50, s50, 20480
    s_add_u32 m0, s37, 9216
    s_nop 0
    buffer_load_dwordx4 v2, s[8:11], s50 offen sc1 lds
    s_lshl_b32 s37, s51, 7
    s_add_u32 s37, s37, 77824
    v_add_u32 v16, s37, v15
    s_lshl_b32 s37, s51, 5
    s_add_u32 s37, s37, 78336
    v_add_u32 v15, s37, v15
    ds_read_b128 v[184:187], v16 offset:0
    ds_read_b128 v[188:191], v16 offset:20992
    ds_read_b128 v[192:195], v16 offset:41984
    ds_read_b128 v[196:199], v16 offset:62976
    ds_read_b128 v[200:203], v16 offset:32
    ds_read_b128 v[204:207], v16 offset:21024
    ds_read_b128 v[208:211], v16 offset:42016
    ds_read_b128 v[212:215], v16 offset:63008
    s_waitcnt lgkmcnt(4)
    v_add_f32 v184, v184, v188
    v_add_f32 v192, v192, v196
    v_add_f32 v185, v185, v189
    v_add_f32 v193, v193, v197
    v_add_f32 v186, v186, v190
    v_add_f32 v194, v194, v198
    v_add_f32 v187, v187, v191
    v_add_f32 v195, v195, v199
    v_add_f32 v216, v184, v192
    v_add_f32 v217, v185, v193
    v_add_f32 v218, v186, v194
    v_add_f32 v219, v187, v195
    ds_read_b128 v[184:187], v16 offset:64
    ds_read_b128 v[188:191], v16 offset:21056
    ds_read_b128 v[192:195], v16 offset:42048
    ds_read_b128 v[196:199], v16 offset:63040
    s_waitcnt lgkmcnt(4)
    v_add_f32 v200, v200, v204
    v_add_f32 v208, v208, v212
    v_add_f32 v201, v201, v205
    v_add_f32 v209, v209, v213
    v_add_f32 v202, v202, v206
    v_add_f32 v210, v210, v214
    v_add_f32 v203, v203, v207
    v_add_f32 v211, v211, v215
    v_add_f32 v220, v200, v208
    v_add_f32 v221, v201, v209
    v_add_f32 v222, v202, v210
    v_add_f32 v223, v203, v211
    ds_read_b128 v[200:203], v16 offset:96
    ds_read_b128 v[204:207], v16 offset:21088
    ds_read_b128 v[208:211], v16 offset:42080
    ds_read_b128 v[212:215], v16 offset:63072
    s_waitcnt lgkmcnt(4)
    v_add_f32 v184, v184, v188
    v_add_f32 v192, v192, v196
    v_add_f32 v185, v185, v189
    v_add_f32 v193, v193, v197
    v_add_f32 v186, v186, v190
    v_add_f32 v194, v194, v198
    v_add_f32 v187, v187, v191
    v_add_f32 v195, v195, v199
    v_add_f32 v224, v184, v192
    v_add_f32 v225, v185, v193
    v_add_f32 v226, v186, v194
    v_add_f32 v227, v187, v195
    ds_read_b128 v[184:187], v15 offset:0
    ds_read_b128 v[188:191], v15 offset:20992
    ds_read_b128 v[192:195], v15 offset:41984
    ds_read_b128 v[196:199], v15 offset:62976
    s_waitcnt lgkmcnt(4)
    v_add_f32 v200, v200, v204
    v_add_f32 v208, v208, v212
    v_add_f32 v201, v201, v205
    v_add_f32 v209, v209, v213
    v_add_f32 v202, v202, v206
    v_add_f32 v210, v210, v214
    v_add_f32 v203, v203, v207
    v_add_f32 v211, v211, v215
    v_add_f32 v228, v200, v208
    v_add_f32 v229, v201, v209
    v_add_f32 v230, v202, v210
    v_add_f32 v231, v203, v211
    s_waitcnt lgkmcnt(0)
    v_add_f32 v184, v184, v188
    v_add_f32 v192, v192, v196
    v_add_f32 v185, v185, v189
    v_add_f32 v193, v193, v197
    v_add_f32 v186, v186, v190
    v_add_f32 v194, v194, v198
    v_add_f32 v187, v187, v191
    v_add_f32 v195, v195, v199
    v_add_f32 v232, v184, v192
    v_add_f32 v233, v185, v193
    v_add_f32 v234, v186, v194
    v_add_f32 v235, v187, v195
    s_mov_b32 s37, 0xbfb8aa3b
    v_mul_f32 v8, s37, v216
    v_mul_f32 v9, s37, v217
    v_mul_f32 v10, s37, v218
    v_mul_f32 v11, s37, v219
    v_exp_f32 v8, v8
    v_exp_f32 v9, v9
    v_exp_f32 v10, v10
    v_exp_f32 v11, v11
    v_add_f32 v8, 1.0, v8
    v_add_f32 v9, 1.0, v9
    v_add_f32 v10, 1.0, v10
    v_add_f32 v11, 1.0, v11
    v_rcp_f32 v8, v8
    v_rcp_f32 v9, v9
    v_rcp_f32 v10, v10
    v_rcp_f32 v11, v11
    v_mul_f32 v216, v216, v8
    v_mul_f32 v217, v217, v9
    v_mul_f32 v218, v218, v10
    v_mul_f32 v219, v219, v11
    v_mul_f32 v8, s37, v220
    v_mul_f32 v9, s37, v221
    v_mul_f32 v10, s37, v222
    v_mul_f32 v11, s37, v223
    v_exp_f32 v8, v8
    v_exp_f32 v9, v9
    v_exp_f32 v10, v10
    v_exp_f32 v11, v11
    v_add_f32 v8, 1.0, v8
    v_add_f32 v9, 1.0, v9
    v_add_f32 v10, 1.0, v10
    v_add_f32 v11, 1.0, v11
    v_rcp_f32 v8, v8
    v_rcp_f32 v9, v9
    v_rcp_f32 v10, v10
    v_rcp_f32 v11, v11
    v_mul_f32 v220, v220, v8
    v_mul_f32 v221, v221, v9
    v_mul_f32 v222, v222, v10
    v_mul_f32 v223, v223, v11
    v_mul_f32 v8, s37, v224
    v_mul_f32 v9, s37, v225
    v_mul_f32 v10, s37, v226
    v_mul_f32 v11, s37, v227
    v_exp_f32 v8, v8
    v_exp_f32 v9, v9
    v_exp_f32 v10, v10
    v_exp_f32 v11, v11
    v_add_f32 v8, 1.0, v8
    v_add_f32 v9, 1.0, v9
    v_add_f32 v10, 1.0, v10
    v_add_f32 v11, 1.0, v11
    v_rcp_f32 v8, v8
    v_rcp_f32 v9, v9
    v_rcp_f32 v10, v10
    v_rcp_f32 v11, v11
    v_mul_f32 v224, v224, v8
    v_mul_f32 v225, v225, v9
    v_mul_f32 v226, v226, v10
    v_mul_f32 v227, v227, v11
    v_mul_f32 v8, s37, v228
    v_mul_f32 v9, s37, v229
    v_mul_f32 v10, s37, v230
    v_mul_f32 v11, s37, v231
    v_exp_f32 v8, v8
    v_exp_f32 v9, v9
    v_exp_f32 v10, v10
    v_exp_f32 v11, v11
    v_add_f32 v8, 1.0, v8
    v_add_f32 v9, 1.0, v9
    v_add_f32 v10, 1.0, v10
    v_add_f32 v11, 1.0, v11
    v_rcp_f32 v8, v8
    v_rcp_f32 v9, v9
    v_rcp_f32 v10, v10
    v_rcp_f32 v11, v11
    v_mul_f32 v228, v228, v8
    v_mul_f32 v229, v229, v9
    v_mul_f32 v230, v230, v10
    v_mul_f32 v231, v231, v11
    v_mul_f32 v8, s37, v232
    v_mul_f32 v9, s37, v233
    v_mul_f32 v10, s37, v234
    v_mul_f32 v11, s37, v235
    v_exp_f32 v8, v8
    v_exp_f32 v9, v9
    v_exp_f32 v10, v10
    v_exp_f32 v11, v11
    v_add_f32 v8, 1.0, v8
    v_add_f32 v9, 1.0, v9
    v_add_f32 v10, 1.0, v10
    v_add_f32 v11, 1.0, v11
    v_rcp_f32 v8, v8
    v_rcp_f32 v9, v9
    v_rcp_f32 v10, v10
    v_rcp_f32 v11, v11
    v_mul_f32 v232, v232, v8
    v_mul_f32 v233, v233, v9
    v_mul_f32 v234, v234, v10
    v_mul_f32 v235, v235, v11
    s_cmp_lg_u32 s51, 0
    s_cbranch_scc1 L_p2_ready
    s_lshl_b32 s37, s52, 8
    s_add_u32 s37, s37, 22216704
    v_mov_b32 v8, 0
    s_mov_b32 s38, 0
L_p2_poll:
    buffer_load_dword v9, v8, s[8:11], s37 offen sc1
    s_add_u32 s38, s38, 1
    s_waitcnt vmcnt(0)
    v_readfirstlane_b32 s3, v9
    s_cmp_ge_u32 s3, 32
    s_cbranch_scc1 L_p2_ready
    s_cmp_ge_u32 s38, 0x40000
    s_cbranch_scc1 L_p2_ready
    s_sleep 2
    s_branch L_p2_poll
L_p2_ready:
    s_waitcnt vmcnt(0) lgkmcnt(0)
    s_barrier
    s_mul_i32 s49, s52, 40
    s_mul_i32 s3, s51, 10
    s_add_u32 s49, s49, s3
    s_lshl_b32 s49, s49, 10
    s_add_u32 s49, s49, 16941056
    s_mul_i32 s37, s51, 10240
    s_add_u32 s37, s37, 40960
    s_add_u32 m0, s37, 0
    s_nop 0
    buffer_load_dwordx4 v2, s[8:11], s49 offen sc1 lds
    s_add_u32 s49, s49, 1024
    s_add_u32 m0, s37, 1024
    s_nop 0
    buffer_load_dwordx4 v2, s[8:11], s49 offen sc1 lds
    s_add_u32 s49, s49, 1024
    s_add_u32 m0, s37, 2048
    s_nop 0
    buffer_load_dwordx4 v2, s[8:11], s49 offen sc1 lds
    s_add_u32 s49, s49, 1024
    s_add_u32 m0, s37, 3072
    s_nop 0
    buffer_load_dwordx4 v2, s[8:11], s49 offen sc1 lds
    s_add_u32 s49, s49, 1024
    s_add_u32 m0, s37, 4096
    s_nop 0
    buffer_load_dwordx4 v2, s[8:11], s49 offen sc1 lds
    s_add_u32 s49, s49, 1024
    s_add_u32 m0, s37, 5120
    s_nop 0
    buffer_load_dwordx4 v2, s[8:11], s49 offen sc1 lds
    s_add_u32 s49, s49, 1024
    s_add_u32 m0, s37, 6144
    s_nop 0
    buffer_load_dwordx4 v2, s[8:11], s49 offen sc1 lds
    s_add_u32 s49, s49, 1024
    s_add_u32 m0, s37, 7168
    s_nop 0
    buffer_load_dwordx4 v2, s[8:11], s49 offen sc1 lds
    s_add_u32 s49, s49, 1024
    s_add_u32 m0, s37, 8192
    s_nop 0
    buffer_load_dwordx4 v2, s[8:11], s49 offen sc1 lds
    s_add_u32 s49, s49, 1024
    s_add_u32 m0, s37, 9216
    s_nop 0
    buffer_load_dwordx4 v2, s[8:11], s49 offen sc1 lds
    s_waitcnt vmcnt(8)
    ds_read_b128 v[246:249], v4 offset:0
    ds_read_b128 v[8:11], v14 offset:0
    ds_read_b128 v[250:253], v4 offset:1024
    ds_read_b128 v[16:19], v14 offset:1024
    s_waitcnt lgkmcnt(2)
    v_mfma_f32_32x32x16_bf16 v[184:199], v[24:27], v[246:249], 0
    v_mfma_f32_32x32x16_bf16 v[200:215], v[8:11], v[246:249], 0
    s_waitcnt vmcnt(6)
    ds_read_b128 v[246:249], v4 offset:2048
    ds_read_b128 v[8:11], v14 offset:2048
    s_waitcnt lgkmcnt(2)
    v_mfma_f32_32x32x16_bf16 v[184:199], v[28:31], v[250:253], v[184:199]
    v_mfma_f32_32x32x16_bf16 v[200:215], v[16:19], v[250:253], v[200:215]
    ds_read_b128 v[250:253], v4 offset:3072
    ds_read_b128 v[16:19], v14 offset:3072
    s_waitcnt lgkmcnt(2)
    v_mfma_f32_32x32x16_bf16 v[184:199], v[32:35], v[246:249], v[184:199]
    v_mfma_f32_32x32x16_bf16 v[200:215], v[8:11], v[246:249], v[200:215]
    s_waitcnt vmcnt(4)
    ds_read_b128 v[246:249], v4 offset:4096
    ds_read_b128 v[8:11], v14 offset:4096
    s_waitcnt lgkmcnt(2)
    v_mfma_f32_32x32x16_bf16 v[184:199], v[36:39], v[250:253], v[184:199]
    v_mfma_f32_32x32x16_bf16 v[200:215], v[16:19], v[250:253], v[200:215]
    ds_read_b128 v[250:253], v4 offset:5120
    ds_read_b128 v[16:19], v14 offset:5120
    s_waitcnt lgkmcnt(2)
    v_mfma_f32_32x32x16_bf16 v[184:199], v[40:43], v[246:249], v[184:199]
    v_mfma_f32_32x32x16_bf16 v[200:215], v[8:11], v[246:249], v[200:215]
    s_waitcnt vmcnt(2)
    ds_read_b128 v[246:249], v4 offset:6144
    ds_read_b128 v[8:11], v14 offset:6144
    s_waitcnt lgkmcnt(2)
    v_mfma_f32_32x32x16_bf16 v[184:199], v[44:47], v[250:253], v[184:199]
    v_mfma_f32_32x32x16_bf16 v[200:215], v[16:19], v[250:253], v[200:215]
    ds_read_b128 v[250:253], v4 offset:7168
    ds_read_b128 v[16:19], v14 offset:7168
    s_waitcnt lgkmcnt(2)
    v_mfma_f32_32x32x16_bf16 v[184:199], v[48:51], v[246:249], v[184:199]
    v_mfma_f32_32x32x16_bf16 v[200:215], v[8:11], v[246:249], v[200:215]
    s_waitcnt vmcnt(0)
    ds_read_b128 v[246:249], v4 offset:8192
    ds_read_b128 v[8:11], v14 offset:8192
    s_waitcnt lgkmcnt(2)
    v_mfma_f32_32x32x16_bf16 v[184:199], v[52:55], v[250:253], v[184:199]
    v_mfma_f32_32x32x16_bf16 v[200:215], v[16:19], v[250:253], v[200:215]
    ds_read_b128 v[250:253], v4 offset:9216
    ds_read_b128 v[16:19], v14 offset:9216
    s_waitcnt lgkmcnt(2)
    v_mfma_f32_32x32x16_bf16 v[184:199], v[56:59], v[246:249], v[184:199]
    v_mfma_f32_32x32x16_bf16 v[200:215], v[8:11], v[246:249], v[200:215]
    s_waitcnt vmcnt(0)
    s_barrier
    ds_read_b128 v[246:249], v5 offset:0
    s_waitcnt lgkmcnt(1)
    v_mfma_f32_32x32x16_bf16 v[184:199], v[60:63], v[250:253], v[184:199]
    v_mfma_f32_32x32x16_bf16 v[200:215], v[16:19], v[250:253], v[200:215]
    ds_read_b128 v[250:253], v5 offset:1024
    s_waitcnt lgkmcnt(1)
    v_mfma_f32_32x32x16_bf16 v[184:199], v[64:67], v[246:249], v[184:199]
    ds_read_b128 v[246:249], v5 offset:2048
    s_waitcnt lgkmcnt(1)
    v_mfma_f32_32x32x16_bf16 v[184:199], v[68:71], v[250:253], v[184:199]
    ds_read_b128 v[250:253], v5 offset:3072
    s_waitcnt lgkmcnt(1)
    v_mfma_f32_32x32x16_bf16 v[184:199], v[72:75], v[246:249], v[184:199]
    ds_read_b128 v[246:249], v5 offset:4096
    s_waitcnt lgkmcnt(1)
    v_mfma_f32_32x32x16_bf16 v[184:199], v[76:79], v[250:253], v[184:199]
    ds_read_b128 v[250:253], v5 offset:5120
    s_waitcnt lgkmcnt(1)
    v_mfma_f32_32x32x16_bf16 v[184:199], v[80:83], v[246:249], v[184:199]
    ds_read_b128 v[246:249], v5 offset:6144
    s_waitcnt lgkmcnt(1)
    v_mfma_f32_32x32x16_bf16 v[184:199], v[84:87], v[250:253], v[184:199]
    ds_read_b128 v[250:253], v5 offset:7168
    s_waitcnt lgkmcnt(1)
    v_mfma_f32_32x32x16_bf16 v[184:199], v[88:91], v[246:249], v[184:199]
    ds_read_b128 v[246:249], v5 offset:8192
    s_waitcnt lgkmcnt(1)
    v_mfma_f32_32x32x16_bf16 v[184:199], v[92:95], v[250:253], v[184:199]
    ds_read_b128 v[250:253], v5 offset:9216
    s_waitcnt lgkmcnt(1)
    v_mfma_f32_32x32x16_bf16 v[184:199], v[96:99], v[246:249], v[184:199]
    ds_read_b128 v[246:249], v6 offset:0
    s_waitcnt lgkmcnt(1)
    v_mfma_f32_32x32x16_bf16 v[184:199], v[100:103], v[250:253], v[184:199]
    ds_read_b128 v[250:253], v6 offset:1024
    s_waitcnt lgkmcnt(1)
    v_mfma_f32_32x32x16_bf16 v[184:199], v[104:107], v[246:249], v[184:199]
    ds_read_b128 v[246:249], v6 offset:2048
    s_waitcnt lgkmcnt(1)
    v_mfma_f32_32x32x16_bf16 v[184:199], v[108:111], v[250:253], v[184:199]
    ds_read_b128 v[250:253], v6 offset:3072
    s_waitcnt lgkmcnt(1)
    v_mfma_f32_32x32x16_bf16 v[184:199], v[112:115], v[246:249], v[184:199]
    ds_read_b128 v[246:249], v6 offset:4096
    s_waitcnt lgkmcnt(1)
    v_mfma_f32_32x32x16_bf16 v[184:199], v[116:119], v[250:253], v[184:199]
    ds_read_b128 v[250:253], v6 offset:5120
    s_waitcnt lgkmcnt(1)
    v_mfma_f32_32x32x16_bf16 v[184:199], v[120:123], v[246:249], v[184:199]
    ds_read_b128 v[246:249], v6 offset:6144
    s_waitcnt lgkmcnt(1)
    v_mfma_f32_32x32x16_bf16 v[184:199], v[124:127], v[250:253], v[184:199]
    ds_read_b128 v[250:253], v6 offset:7168
    s_waitcnt lgkmcnt(1)
    v_mfma_f32_32x32x16_bf16 v[184:199], v[128:131], v[246:249], v[184:199]
    ds_read_b128 v[246:249], v6 offset:8192
    s_waitcnt lgkmcnt(1)
    v_mfma_f32_32x32x16_bf16 v[184:199], v[132:135], v[250:253], v[184:199]
    ds_read_b128 v[250:253], v6 offset:9216
    s_waitcnt lgkmcnt(1)
    v_mfma_f32_32x32x16_bf16 v[184:199], v[136:139], v[246:249], v[184:199]
    ds_read_b128 v[246:249], v7 offset:0
    s_waitcnt lgkmcnt(1)
    v_mfma_f32_32x32x16_bf16 v[184:199], v[140:143], v[250:253], v[184:199]
    ds_read_b128 v[250:253], v7 offset:1024
    s_waitcnt lgkmcnt(1)
    v_mfma_f32_32x32x16_bf16 v[184:199], v[144:147], v[246:249], v[184:199]
    ds_read_b128 v[246:249], v7 offset:2048
    s_waitcnt lgkmcnt(1)
    v_mfma_f32_32x32x16_bf16 v[184:199], v[148:151], v[250:253], v[184:199]
    ds_read_b128 v[250:253], v7 offset:3072
    s_waitcnt lgkmcnt(1)
    v_mfma_f32_32x32x16_bf16 v[184:199], v[152:155], v[246:249], v[184:199]
    ds_read_b128 v[246:249], v7 offset:4096
    s_waitcnt lgkmcnt(1)
    v_mfma_f32_32x32x16_bf16 v[184:199], v[156:159], v[250:253], v[184:199]
    ds_read_b128 v[250:253], v7 offset:5120
    s_waitcnt lgkmcnt(1)
    v_mfma_f32_32x32x16_bf16 v[184:199], v[160:163], v[246:249], v[184:199]
    ds_read_b128 v[246:249], v7 offset:6144
    s_waitcnt lgkmcnt(1)
    v_mfma_f32_32x32x16_bf16 v[184:199], v[164:167], v[250:253], v[184:199]
    ds_read_b128 v[250:253], v7 offset:7168
    s_waitcnt lgkmcnt(1)
    v_mfma_f32_32x32x16_bf16 v[184:199], v[168:171], v[246:249], v[184:199]
    ds_read_b128 v[246:249], v7 offset:8192
    s_waitcnt lgkmcnt(1)
    v_mfma_f32_32x32x16_bf16 v[184:199], v[172:175], v[250:253], v[184:199]
    ds_read_b128 v[250:253], v7 offset:9216
    s_waitcnt lgkmcnt(1)
    v_mfma_f32_32x32x16_bf16 v[184:199], v[176:179], v[246:249], v[184:199]
    s_waitcnt lgkmcnt(0)
    v_mfma_f32_32x32x16_bf16 v[184:199], v[180:183], v[250:253], v[184:199]
    s_lshl_b32 s37, s51, 12
    s_add_u32 s37, s37, 81920
    v_add_u32 v14, s37, v2
    s_lshl_b32 s37, s51, 10
    s_add_u32 s37, s37, 81920
    v_add_u32 v15, s37, v2
    ds_write_b128 v14, v[200:203] offset:0
    ds_write_b128 v14, v[204:207] offset:1024
    ds_write_b128 v14, v[208:211] offset:2048
    ds_write_b128 v14, v[212:215] offset:3072
    s_waitcnt lgkmcnt(0)
    s_barrier
    ds_read_b128 v[24:27], v15 offset:0
    ds_read_b128 v[28:31], v15 offset:4096
    ds_read_b128 v[32:35], v15 offset:8192
    ds_read_b128 v[36:39], v15 offset:12288
    v_lshlrev_b32 v40, 16, v236
    v_and_b32 v41, 0xffff0000, v236
    v_lshlrev_b32 v42, 16, v237
    v_and_b32 v43, 0xffff0000, v237
    v_fma_f32 v40, v184, v216, v40
    v_fma_f32 v41, v185, v217, v41
    v_fma_f32 v42, v186, v218, v42
    v_fma_f32 v43, v187, v219, v43
    v_cvt_pk_bf16_f32 v48, v40, v41
    v_cvt_pk_bf16_f32 v49, v42, v43
    v_lshlrev_b32 v40, 16, v238
    v_and_b32 v41, 0xffff0000, v238
    v_lshlrev_b32 v42, 16, v239
    v_and_b32 v43, 0xffff0000, v239
    v_fma_f32 v40, v188, v220, v40
    v_fma_f32 v41, v189, v221, v41
    v_fma_f32 v42, v190, v222, v42
    v_fma_f32 v43, v191, v223, v43
    v_cvt_pk_bf16_f32 v50, v40, v41
    v_cvt_pk_bf16_f32 v51, v42, v43
    v_lshlrev_b32 v40, 16, v240
    v_and_b32 v41, 0xffff0000, v240
    v_lshlrev_b32 v42, 16, v241
    v_and_b32 v43, 0xffff0000, v241
    v_fma_f32 v40, v192, v224, v40
    v_fma_f32 v41, v193, v225, v41
    v_fma_f32 v42, v194, v226, v42
    v_fma_f32 v43, v195, v227, v43
    v_cvt_pk_bf16_f32 v52, v40, v41
    v_cvt_pk_bf16_f32 v53, v42, v43
    v_lshlrev_b32 v40, 16, v242
    v_and_b32 v41, 0xffff0000, v242
    v_lshlrev_b32 v42, 16, v243
    v_and_b32 v43, 0xffff0000, v243
    v_fma_f32 v40, v196, v228, v40
    v_fma_f32 v41, v197, v229, v41
    v_fma_f32 v42, v198, v230, v42
    v_fma_f32 v43, v199, v231, v43
    v_cvt_pk_bf16_f32 v54, v40, v41
    v_cvt_pk_bf16_f32 v55, v42, v43
    v_permlane32_swap_b32 v48, v50
    v_permlane32_swap_b32 v49, v51
    v_permlane32_swap_b32 v52, v54
    v_permlane32_swap_b32 v53, v55
    buffer_store_dwordx4 v[48:51], v13, s[20:23], s55 offen
    buffer_store_dwordx4 v[52:55], v13, s[20:23], s55 offen offset:32
    s_waitcnt lgkmcnt(0)
    v_add_f32 v24, v24, v28
    v_add_f32 v32, v32, v36
    v_add_f32 v25, v25, v29
    v_add_f32 v33, v33, v37
    v_add_f32 v26, v26, v30
    v_add_f32 v34, v34, v38
    v_add_f32 v27, v27, v31
    v_add_f32 v35, v35, v39
    v_add_f32 v24, v24, v32
    v_add_f32 v25, v25, v33
    v_add_f32 v26, v26, v34
    v_add_f32 v27, v27, v35
    v_lshlrev_b32 v40, 16, v244
    v_and_b32 v41, 0xffff0000, v244
    v_lshlrev_b32 v42, 16, v245
    v_and_b32 v43, 0xffff0000, v245
    v_fma_f32 v40, v24, v232, v40
    v_fma_f32 v41, v25, v233, v41
    v_fma_f32 v42, v26, v234, v42
    v_fma_f32 v43, v27, v235, v43
    v_cvt_pk_bf16_f32 v56, v40, v41
    v_cvt_pk_bf16_f32 v57, v42, v43
    buffer_store_dwordx2 v[56:57], v12, s[20:23], s56 offen
L_p2_end:
L_p2_exit:
    s_endpgm
CODE_END:
.section .rodata,"a"
.p2align 6
.amdhsa_kernel recurrent_scan__softmax_full_mha__dense_activation_relu__prompt_kernel
  .amdhsa_next_free_vgpr 254
  .amdhsa_next_free_sgpr 100
  .amdhsa_accum_offset 256
  .amdhsa_group_segment_fixed_size 0
  .amdhsa_kernarg_size 72
  .amdhsa_user_sgpr_count 2
  .amdhsa_user_sgpr_kernarg_segment_ptr 1
  .amdhsa_system_sgpr_workgroup_id_x 1
  .amdhsa_float_denorm_mode_32 3
.end_amdhsa_kernel
.text
```
